```python
import torch

def _softmax(x, axis=-1):
    return torch.softmax(x, dim=axis)

def _gelu(x):
    return torch.nn.functional.gelu(x, approximate='tanh')

def _silu(x):
    return torch.nn.functional.silu(x)

def _sigmoid(x):
    return torch.sigmoid(x)

def _layernorm(x, axis=-1, eps=1e-05):
    m = x.mean(dim=axis, keepdim=True)
    v = x.var(dim=axis, keepdim=True, unbiased=False)
    return (x - m) / torch.sqrt(v + eps)

def _scatter_add(tgt, idx, src, axis=0):
    return tgt.clone().index_add_(axis, idx, src)

def _segment_sum(src, seg, n):
    out = torch.zeros((n,) + src.shape[1:], dtype=src.dtype)
    return out.index_add_(0, seg, src)

def _pad(x, pw):
    flat = tuple((v for pair in reversed(pw) for v in pair))
    return torch.nn.functional.pad(x, flat)
kernel_name = 'adaLN_cond__ssm_conv_s4__dense_activation_squared_relu__prompt'

def setup_inputs():

    _w = lambda a: (lambda t: t.to(torch.bfloat16) if t.is_floating_point() else t)(torch.as_tensor(a))

    def _A_setup():
        B, L, D, N = (1, 2048, 512, 128)
        A_re = -(lambda _x: torch.exp(torch.as_tensor(_x)))((lambda *s: torch.randn(*s, dtype=torch.bfloat16) * 12.8)(D, N))
        A_im = torch.pi * (lambda *s: torch.randn(*s, dtype=torch.bfloat16) * 0.1)(D, N)
        B_re = (lambda *s: torch.randn(*s, dtype=torch.bfloat16) * 0.2)(D, N)
        B_im = (lambda *s: torch.randn(*s, dtype=torch.bfloat16) * 0.2)(D, N)
        C_re = (lambda *s: torch.randn(*s, dtype=torch.bfloat16) * 0.2)(D, N)
        C_im = (lambda *s: torch.randn(*s, dtype=torch.bfloat16) * 0.2)(D, N)
        log_dt = (lambda *s: torch.randn(*s, dtype=torch.bfloat16) * 0.1)(D) * 0.5 - 4.0
        Dskip = (lambda *s: torch.randn(*s, dtype=torch.bfloat16) * 0.1)(D)
        return {'u': _w((lambda *s: torch.randn(*s, dtype=torch.bfloat16) * 0.05)(B, L, D)), 'A_re': _w(A_re), 'A_im': _w(A_im), 'B_re': _w(B_re), 'B_im': _w(B_im), 'C_re': _w(C_re), 'C_im': _w(C_im), 'log_dt': _w(log_dt), 'Dskip': _w(Dskip)}
    _A_in = _A_setup()

    def _B_setup():
        B, S, D, F = (1, 2048, 512, 1792)
        return {'x': _w((lambda *s: torch.randn(*s, dtype=torch.bfloat16) * 0.05)(B, S, D)), 'w1': _w((lambda *s: torch.randn(*s, dtype=torch.bfloat16) * 0.05)(D, F)), 'b1': _w((lambda *s: torch.randn(*s, dtype=torch.bfloat16) * 1.6)(F)), 'w2': _w((lambda *s: torch.randn(*s, dtype=torch.bfloat16) * 0.05)(F, D)), 'b2': _w((lambda *s: torch.randn(*s, dtype=torch.bfloat16) * 12.8)(D))}
    _B_in = _B_setup()
    return {'A_u': _A_in['u'], 'A_A_re': _A_in['A_re'], 'A_A_im': _A_in['A_im'], 'A_B_re': _A_in['B_re'], 'A_B_im': _A_in['B_im'], 'A_C_re': _A_in['C_re'], 'A_C_im': _A_in['C_im'], 'A_log_dt': _A_in['log_dt'], 'A_Dskip': _A_in['Dskip'], 'B_x': _B_in['x'], 'B_w1': _B_in['w1'], 'B_b1': _B_in['b1'], 'B_w2': _B_in['w2'], 'B_b2': _B_in['b2'], 'c': _w((lambda *s: torch.randn(*s, dtype=torch.bfloat16) * 0.2)(1, 512) * 8.0), 'w_mod': _w((lambda *s: torch.randn(*s, dtype=torch.bfloat16) * 0.2)(512, 6 * 512) * 512 ** (-0.5) * 8.0)}

def reference(A_u, A_A_re, A_A_im, A_B_re, A_B_im, A_C_re, A_C_im, A_log_dt, A_Dskip, B_x, B_w1, B_b1, B_w2, B_b2, c, w_mod):

    def _A_ref(u, A_re, A_im, B_re, B_im, C_re, C_im, log_dt, Dskip):
        Bsz, L, D = u.shape
        dt = torch.exp(log_dt)[:, None]
        A = A_re + 1j * A_im
        Bc = B_re + 1j * B_im
        Cc = C_re + 1j * C_im
        logdA = dt * A
        dB = dt * Bc
        l = (lambda x, dt: x.to(dt))(torch.arange(L), A_re.dtype)
        P = torch.exp(logdA[:, :, None] * l[None, None, :])
        K = torch.einsum('dn,dnl,dn->dl', Cc, P, dB).real
        L2 = 2 * L
        Kp = _pad(K, ((0, 0), (0, L)))
        up = (lambda x, *d: x.permute(*d))(u, 0, 2, 1)
        up = _pad(up, ((0, 0), (0, 0), (0, L)))
        Kf = (lambda x, axes=(-2, -1): torch.fft.rfft2(x.float(), dim=axes))(Kp[:, None, :], axes=(-2, -1))
        Uf = (lambda x, axes=(-2, -1): torch.fft.rfft2(x.float(), dim=axes))(up[:, :, None, :], axes=(-2, -1))
        Yf = Uf * Kf[None, :, :, :]
        y = (lambda x, s, axes=(-2, -1): torch.fft.irfft2(x, s=s, dim=axes).to(torch.bfloat16))(Yf, (1, L2), axes=(-2, -1))[:, :, 0, :L]
        y = (lambda x, *d: x.permute(*d))(y, 0, 2, 1) + u * Dskip[None, None, :]
        return y

    def _B_ref(x, w1, b1, w2, b2):
        h = torch.einsum('bsd,df->bsf', x, w1) + b1
        zero = torch.zeros_like(h)
        r = torch.where(h > zero, h, zero)
        h = r * r
        out = torch.einsum('bsf,fd->bsd', h, w2) + b2
        return out
    x = A_u
    mod = (_silu(c) @ w_mod).reshape(c.shape[0], 6, 1, -1)
    sa, ca, ga, sb, cb, gb = (mod[:, 0].clone(), mod[:, 1].clone(), mod[:, 2].clone(), mod[:, 3].clone(), mod[:, 4].clone(), mod[:, 5].clone())
    h = _layernorm(x, axis=-1) * (1 + ca) + sa
    x = x + ga * _A_ref(h, A_A_re, A_A_im, A_B_re, A_B_im, A_C_re, A_C_im, A_log_dt, A_Dskip)
    h = _layernorm(x, axis=-1) * (1 + cb) + sb
    x = x + gb * _B_ref(h, B_w1, B_b1, B_w2, B_b2)
    return x
```

```asm
; @launch kernel=pc_kernel grid=(744,1,1) block=(256,1,1) lds=47680
; @launch kernel=ffn_kernel grid=(256,1,1) block=(512,1,1) lds=135168
.amdgcn_target "amdgcn-amd-amdhsa--gfx950"
.text
.globl pc_kernel
.p2align 8
.type pc_kernel,@function
pc_kernel:
    s_load_dwordx2 s[4:5], s[0:1], 144
    s_mov_b32 s6, 0x2000000
    s_mov_b32 s7, 0x00020000
    s_load_dwordx2 s[56:57], s[0:1], 136
    s_mov_b32 s58, 0x100
    s_mov_b32 s59, 0x00020000
    s_cmp_ge_u32 s2, 744
    s_cbranch_scc1 P_END
    s_cmp_ge_u32 s2, 232
    s_cbranch_scc1 C_CV
    s_cmp_ge_u32 s2, 176
    s_cbranch_scc1 P_W2
    s_cmp_ge_u32 s2, 48
    s_cbranch_scc1 P_LN
    s_load_dwordx2 s[8:9], s[0:1], 120
    s_mov_b32 s10, 0x300000
    s_mov_b32 s11, 0x00020000
    s_load_dwordx2 s[12:13], s[0:1], 112
    s_mov_b32 s14, 0x400
    s_mov_b32 s15, 0x00020000
    v_and_b32 v1, 7, v0
    v_lshrrev_b32 v2, 3, v0
    v_mul_u32_u24 v3, 98304, v2
    v_lshl_add_u32 v3, v1, 4, v3
    s_lshl_b32 s17, s2, 7
    v_lshlrev_b32 v4, 5, v2
    s_waitcnt lgkmcnt(0)
    buffer_load_dwordx4 v[8:11], v4, s[12:15], 0 offen
    buffer_load_dwordx4 v[12:15], v4, s[12:15], 0 offen offset:16
    buffer_load_dwordx4 v[48:51], v3, s[8:11], s17 offen
    s_add_u32 s17, s17, 6144
    buffer_load_dwordx4 v[52:55], v3, s[8:11], s17 offen
    s_add_u32 s17, s17, 6144
    buffer_load_dwordx4 v[56:59], v3, s[8:11], s17 offen
    s_add_u32 s17, s17, 6144
    buffer_load_dwordx4 v[60:63], v3, s[8:11], s17 offen
    s_add_u32 s17, s17, 6144
    buffer_load_dwordx4 v[64:67], v3, s[8:11], s17 offen
    s_add_u32 s17, s17, 6144
    buffer_load_dwordx4 v[68:71], v3, s[8:11], s17 offen
    s_add_u32 s17, s17, 6144
    buffer_load_dwordx4 v[72:75], v3, s[8:11], s17 offen
    s_add_u32 s17, s17, 6144
    buffer_load_dwordx4 v[76:79], v3, s[8:11], s17 offen
    s_add_u32 s17, s17, 6144
    buffer_load_dwordx4 v[80:83], v3, s[8:11], s17 offen
    s_add_u32 s17, s17, 6144
    buffer_load_dwordx4 v[84:87], v3, s[8:11], s17 offen
    s_add_u32 s17, s17, 6144
    buffer_load_dwordx4 v[88:91], v3, s[8:11], s17 offen
    s_add_u32 s17, s17, 6144
    buffer_load_dwordx4 v[92:95], v3, s[8:11], s17 offen
    s_add_u32 s17, s17, 6144
    buffer_load_dwordx4 v[96:99], v3, s[8:11], s17 offen
    s_add_u32 s17, s17, 6144
    buffer_load_dwordx4 v[100:103], v3, s[8:11], s17 offen
    s_add_u32 s17, s17, 6144
    buffer_load_dwordx4 v[104:107], v3, s[8:11], s17 offen
    s_add_u32 s17, s17, 6144
    buffer_load_dwordx4 v[108:111], v3, s[8:11], s17 offen
    s_add_u32 s17, s17, 6144
    v_lshlrev_b32 v5, 7, v0
    v_mov_b32 v6, 0
    s_mov_b32 s18, 0x8000
    s_waitcnt vmcnt(16)
    v_lshlrev_b32 v16, 16, v8
    v_and_b32 v17, 0xffff0000, v8
    v_lshlrev_b32 v18, 16, v9
    v_and_b32 v19, 0xffff0000, v9
    v_lshlrev_b32 v20, 16, v10
    v_and_b32 v21, 0xffff0000, v10
    v_lshlrev_b32 v22, 16, v11
    v_and_b32 v23, 0xffff0000, v11
    v_lshlrev_b32 v24, 16, v12
    v_and_b32 v25, 0xffff0000, v12
    v_lshlrev_b32 v26, 16, v13
    v_and_b32 v27, 0xffff0000, v13
    v_lshlrev_b32 v28, 16, v14
    v_and_b32 v29, 0xffff0000, v14
    v_lshlrev_b32 v30, 16, v15
    v_and_b32 v31, 0xffff0000, v15
    v_mul_f32 v32, 0xbfb8aa3b, v16
    v_mul_f32 v33, 0xbfb8aa3b, v17
    v_mul_f32 v34, 0xbfb8aa3b, v18
    v_mul_f32 v35, 0xbfb8aa3b, v19
    v_mul_f32 v36, 0xbfb8aa3b, v20
    v_mul_f32 v37, 0xbfb8aa3b, v21
    v_mul_f32 v38, 0xbfb8aa3b, v22
    v_mul_f32 v39, 0xbfb8aa3b, v23
    v_mul_f32 v40, 0xbfb8aa3b, v24
    v_mul_f32 v41, 0xbfb8aa3b, v25
    v_mul_f32 v42, 0xbfb8aa3b, v26
    v_mul_f32 v43, 0xbfb8aa3b, v27
    v_mul_f32 v44, 0xbfb8aa3b, v28
    v_mul_f32 v45, 0xbfb8aa3b, v29
    v_mul_f32 v46, 0xbfb8aa3b, v30
    v_mul_f32 v47, 0xbfb8aa3b, v31
    v_exp_f32 v32, v32
    v_exp_f32 v33, v33
    v_exp_f32 v34, v34
    v_exp_f32 v35, v35
    v_exp_f32 v36, v36
    v_exp_f32 v37, v37
    v_exp_f32 v38, v38
    v_exp_f32 v39, v39
    v_exp_f32 v40, v40
    v_exp_f32 v41, v41
    v_exp_f32 v42, v42
    v_exp_f32 v43, v43
    v_exp_f32 v44, v44
    v_exp_f32 v45, v45
    v_exp_f32 v46, v46
    v_exp_f32 v47, v47
    v_add_f32 v32, 1.0, v32
    v_add_f32 v33, 1.0, v33
    v_add_f32 v34, 1.0, v34
    v_add_f32 v35, 1.0, v35
    v_add_f32 v36, 1.0, v36
    v_add_f32 v37, 1.0, v37
    v_add_f32 v38, 1.0, v38
    v_add_f32 v39, 1.0, v39
    v_add_f32 v40, 1.0, v40
    v_add_f32 v41, 1.0, v41
    v_add_f32 v42, 1.0, v42
    v_add_f32 v43, 1.0, v43
    v_add_f32 v44, 1.0, v44
    v_add_f32 v45, 1.0, v45
    v_add_f32 v46, 1.0, v46
    v_add_f32 v47, 1.0, v47
    v_rcp_f32 v32, v32
    v_rcp_f32 v33, v33
    v_rcp_f32 v34, v34
    v_rcp_f32 v35, v35
    v_rcp_f32 v36, v36
    v_rcp_f32 v37, v37
    v_rcp_f32 v38, v38
    v_rcp_f32 v39, v39
    v_rcp_f32 v40, v40
    v_rcp_f32 v41, v41
    v_rcp_f32 v42, v42
    v_rcp_f32 v43, v43
    v_rcp_f32 v44, v44
    v_rcp_f32 v45, v45
    v_rcp_f32 v46, v46
    v_rcp_f32 v47, v47
    v_mul_f32 v16, v16, v32
    v_mul_f32 v17, v17, v33
    v_mul_f32 v18, v18, v34
    v_mul_f32 v19, v19, v35
    v_mul_f32 v20, v20, v36
    v_mul_f32 v21, v21, v37
    v_mul_f32 v22, v22, v38
    v_mul_f32 v23, v23, v39
    v_mul_f32 v24, v24, v40
    v_mul_f32 v25, v25, v41
    v_mul_f32 v26, v26, v42
    v_mul_f32 v27, v27, v43
    v_mul_f32 v28, v28, v44
    v_mul_f32 v29, v29, v45
    v_mul_f32 v30, v30, v46
    v_mul_f32 v31, v31, v47
    v_cvt_pk_bf16_f32 v16, v16, v16
    v_and_b32 v16, 0xffff0000, v16
    v_cvt_pk_bf16_f32 v17, v17, v17
    v_and_b32 v17, 0xffff0000, v17
    v_cvt_pk_bf16_f32 v18, v18, v18
    v_and_b32 v18, 0xffff0000, v18
    v_cvt_pk_bf16_f32 v19, v19, v19
    v_and_b32 v19, 0xffff0000, v19
    v_cvt_pk_bf16_f32 v20, v20, v20
    v_and_b32 v20, 0xffff0000, v20
    v_cvt_pk_bf16_f32 v21, v21, v21
    v_and_b32 v21, 0xffff0000, v21
    v_cvt_pk_bf16_f32 v22, v22, v22
    v_and_b32 v22, 0xffff0000, v22
    v_cvt_pk_bf16_f32 v23, v23, v23
    v_and_b32 v23, 0xffff0000, v23
    v_cvt_pk_bf16_f32 v24, v24, v24
    v_and_b32 v24, 0xffff0000, v24
    v_cvt_pk_bf16_f32 v25, v25, v25
    v_and_b32 v25, 0xffff0000, v25
    v_cvt_pk_bf16_f32 v26, v26, v26
    v_and_b32 v26, 0xffff0000, v26
    v_cvt_pk_bf16_f32 v27, v27, v27
    v_and_b32 v27, 0xffff0000, v27
    v_cvt_pk_bf16_f32 v28, v28, v28
    v_and_b32 v28, 0xffff0000, v28
    v_cvt_pk_bf16_f32 v29, v29, v29
    v_and_b32 v29, 0xffff0000, v29
    v_cvt_pk_bf16_f32 v30, v30, v30
    v_and_b32 v30, 0xffff0000, v30
    v_cvt_pk_bf16_f32 v31, v31, v31
    v_and_b32 v31, 0xffff0000, v31
    v_mov_b32 v32, 0
    v_mov_b32 v33, 0
    v_mov_b32 v34, 0
    v_mov_b32 v35, 0
    v_mov_b32 v36, 0
    v_mov_b32 v37, 0
    v_mov_b32 v38, 0
    v_mov_b32 v39, 0
    s_waitcnt vmcnt(15)
    v_lshlrev_b32 v40, 16, v48
    v_and_b32 v41, 0xffff0000, v48
    v_lshlrev_b32 v42, 16, v49
    v_and_b32 v43, 0xffff0000, v49
    v_lshlrev_b32 v44, 16, v50
    v_and_b32 v45, 0xffff0000, v50
    v_lshlrev_b32 v46, 16, v51
    v_and_b32 v47, 0xffff0000, v51
    v_fmac_f32 v32, v40, v16
    v_fmac_f32 v33, v41, v16
    v_fmac_f32 v34, v42, v16
    v_fmac_f32 v35, v43, v16
    v_fmac_f32 v36, v44, v16
    v_fmac_f32 v37, v45, v16
    v_fmac_f32 v38, v46, v16
    v_fmac_f32 v39, v47, v16
    s_waitcnt vmcnt(14)
    v_lshlrev_b32 v40, 16, v52
    v_and_b32 v41, 0xffff0000, v52
    v_lshlrev_b32 v42, 16, v53
    v_and_b32 v43, 0xffff0000, v53
    v_lshlrev_b32 v44, 16, v54
    v_and_b32 v45, 0xffff0000, v54
    v_lshlrev_b32 v46, 16, v55
    v_and_b32 v47, 0xffff0000, v55
    v_fmac_f32 v32, v40, v17
    v_fmac_f32 v33, v41, v17
    v_fmac_f32 v34, v42, v17
    v_fmac_f32 v35, v43, v17
    v_fmac_f32 v36, v44, v17
    v_fmac_f32 v37, v45, v17
    v_fmac_f32 v38, v46, v17
    v_fmac_f32 v39, v47, v17
    s_waitcnt vmcnt(13)
    v_lshlrev_b32 v40, 16, v56
    v_and_b32 v41, 0xffff0000, v56
    v_lshlrev_b32 v42, 16, v57
    v_and_b32 v43, 0xffff0000, v57
    v_lshlrev_b32 v44, 16, v58
    v_and_b32 v45, 0xffff0000, v58
    v_lshlrev_b32 v46, 16, v59
    v_and_b32 v47, 0xffff0000, v59
    v_fmac_f32 v32, v40, v18
    v_fmac_f32 v33, v41, v18
    v_fmac_f32 v34, v42, v18
    v_fmac_f32 v35, v43, v18
    v_fmac_f32 v36, v44, v18
    v_fmac_f32 v37, v45, v18
    v_fmac_f32 v38, v46, v18
    v_fmac_f32 v39, v47, v18
    s_waitcnt vmcnt(12)
    v_lshlrev_b32 v40, 16, v60
    v_and_b32 v41, 0xffff0000, v60
    v_lshlrev_b32 v42, 16, v61
    v_and_b32 v43, 0xffff0000, v61
    v_lshlrev_b32 v44, 16, v62
    v_and_b32 v45, 0xffff0000, v62
    v_lshlrev_b32 v46, 16, v63
    v_and_b32 v47, 0xffff0000, v63
    v_fmac_f32 v32, v40, v19
    v_fmac_f32 v33, v41, v19
    v_fmac_f32 v34, v42, v19
    v_fmac_f32 v35, v43, v19
    v_fmac_f32 v36, v44, v19
    v_fmac_f32 v37, v45, v19
    v_fmac_f32 v38, v46, v19
    v_fmac_f32 v39, v47, v19
    s_waitcnt vmcnt(11)
    v_lshlrev_b32 v40, 16, v64
    v_and_b32 v41, 0xffff0000, v64
    v_lshlrev_b32 v42, 16, v65
    v_and_b32 v43, 0xffff0000, v65
    v_lshlrev_b32 v44, 16, v66
    v_and_b32 v45, 0xffff0000, v66
    v_lshlrev_b32 v46, 16, v67
    v_and_b32 v47, 0xffff0000, v67
    v_fmac_f32 v32, v40, v20
    v_fmac_f32 v33, v41, v20
    v_fmac_f32 v34, v42, v20
    v_fmac_f32 v35, v43, v20
    v_fmac_f32 v36, v44, v20
    v_fmac_f32 v37, v45, v20
    v_fmac_f32 v38, v46, v20
    v_fmac_f32 v39, v47, v20
    s_waitcnt vmcnt(10)
    v_lshlrev_b32 v40, 16, v68
    v_and_b32 v41, 0xffff0000, v68
    v_lshlrev_b32 v42, 16, v69
    v_and_b32 v43, 0xffff0000, v69
    v_lshlrev_b32 v44, 16, v70
    v_and_b32 v45, 0xffff0000, v70
    v_lshlrev_b32 v46, 16, v71
    v_and_b32 v47, 0xffff0000, v71
    v_fmac_f32 v32, v40, v21
    v_fmac_f32 v33, v41, v21
    v_fmac_f32 v34, v42, v21
    v_fmac_f32 v35, v43, v21
    v_fmac_f32 v36, v44, v21
    v_fmac_f32 v37, v45, v21
    v_fmac_f32 v38, v46, v21
    v_fmac_f32 v39, v47, v21
    s_waitcnt vmcnt(9)
    v_lshlrev_b32 v40, 16, v72
    v_and_b32 v41, 0xffff0000, v72
    v_lshlrev_b32 v42, 16, v73
    v_and_b32 v43, 0xffff0000, v73
    v_lshlrev_b32 v44, 16, v74
    v_and_b32 v45, 0xffff0000, v74
    v_lshlrev_b32 v46, 16, v75
    v_and_b32 v47, 0xffff0000, v75
    v_fmac_f32 v32, v40, v22
    v_fmac_f32 v33, v41, v22
    v_fmac_f32 v34, v42, v22
    v_fmac_f32 v35, v43, v22
    v_fmac_f32 v36, v44, v22
    v_fmac_f32 v37, v45, v22
    v_fmac_f32 v38, v46, v22
    v_fmac_f32 v39, v47, v22
    s_waitcnt vmcnt(8)
    v_lshlrev_b32 v40, 16, v76
    v_and_b32 v41, 0xffff0000, v76
    v_lshlrev_b32 v42, 16, v77
    v_and_b32 v43, 0xffff0000, v77
    v_lshlrev_b32 v44, 16, v78
    v_and_b32 v45, 0xffff0000, v78
    v_lshlrev_b32 v46, 16, v79
    v_and_b32 v47, 0xffff0000, v79
    v_fmac_f32 v32, v40, v23
    v_fmac_f32 v33, v41, v23
    v_fmac_f32 v34, v42, v23
    v_fmac_f32 v35, v43, v23
    v_fmac_f32 v36, v44, v23
    v_fmac_f32 v37, v45, v23
    v_fmac_f32 v38, v46, v23
    v_fmac_f32 v39, v47, v23
    s_waitcnt vmcnt(7)
    v_lshlrev_b32 v40, 16, v80
    v_and_b32 v41, 0xffff0000, v80
    v_lshlrev_b32 v42, 16, v81
    v_and_b32 v43, 0xffff0000, v81
    v_lshlrev_b32 v44, 16, v82
    v_and_b32 v45, 0xffff0000, v82
    v_lshlrev_b32 v46, 16, v83
    v_and_b32 v47, 0xffff0000, v83
    v_fmac_f32 v32, v40, v24
    v_fmac_f32 v33, v41, v24
    v_fmac_f32 v34, v42, v24
    v_fmac_f32 v35, v43, v24
    v_fmac_f32 v36, v44, v24
    v_fmac_f32 v37, v45, v24
    v_fmac_f32 v38, v46, v24
    v_fmac_f32 v39, v47, v24
    s_waitcnt vmcnt(6)
    v_lshlrev_b32 v40, 16, v84
    v_and_b32 v41, 0xffff0000, v84
    v_lshlrev_b32 v42, 16, v85
    v_and_b32 v43, 0xffff0000, v85
    v_lshlrev_b32 v44, 16, v86
    v_and_b32 v45, 0xffff0000, v86
    v_lshlrev_b32 v46, 16, v87
    v_and_b32 v47, 0xffff0000, v87
    v_fmac_f32 v32, v40, v25
    v_fmac_f32 v33, v41, v25
    v_fmac_f32 v34, v42, v25
    v_fmac_f32 v35, v43, v25
    v_fmac_f32 v36, v44, v25
    v_fmac_f32 v37, v45, v25
    v_fmac_f32 v38, v46, v25
    v_fmac_f32 v39, v47, v25
    s_waitcnt vmcnt(5)
    v_lshlrev_b32 v40, 16, v88
    v_and_b32 v41, 0xffff0000, v88
    v_lshlrev_b32 v42, 16, v89
    v_and_b32 v43, 0xffff0000, v89
    v_lshlrev_b32 v44, 16, v90
    v_and_b32 v45, 0xffff0000, v90
    v_lshlrev_b32 v46, 16, v91
    v_and_b32 v47, 0xffff0000, v91
    v_fmac_f32 v32, v40, v26
    v_fmac_f32 v33, v41, v26
    v_fmac_f32 v34, v42, v26
    v_fmac_f32 v35, v43, v26
    v_fmac_f32 v36, v44, v26
    v_fmac_f32 v37, v45, v26
    v_fmac_f32 v38, v46, v26
    v_fmac_f32 v39, v47, v26
    s_waitcnt vmcnt(4)
    v_lshlrev_b32 v40, 16, v92
    v_and_b32 v41, 0xffff0000, v92
    v_lshlrev_b32 v42, 16, v93
    v_and_b32 v43, 0xffff0000, v93
    v_lshlrev_b32 v44, 16, v94
    v_and_b32 v45, 0xffff0000, v94
    v_lshlrev_b32 v46, 16, v95
    v_and_b32 v47, 0xffff0000, v95
    v_fmac_f32 v32, v40, v27
    v_fmac_f32 v33, v41, v27
    v_fmac_f32 v34, v42, v27
    v_fmac_f32 v35, v43, v27
    v_fmac_f32 v36, v44, v27
    v_fmac_f32 v37, v45, v27
    v_fmac_f32 v38, v46, v27
    v_fmac_f32 v39, v47, v27
    s_waitcnt vmcnt(3)
    v_lshlrev_b32 v40, 16, v96
    v_and_b32 v41, 0xffff0000, v96
    v_lshlrev_b32 v42, 16, v97
    v_and_b32 v43, 0xffff0000, v97
    v_lshlrev_b32 v44, 16, v98
    v_and_b32 v45, 0xffff0000, v98
    v_lshlrev_b32 v46, 16, v99
    v_and_b32 v47, 0xffff0000, v99
    v_fmac_f32 v32, v40, v28
    v_fmac_f32 v33, v41, v28
    v_fmac_f32 v34, v42, v28
    v_fmac_f32 v35, v43, v28
    v_fmac_f32 v36, v44, v28
    v_fmac_f32 v37, v45, v28
    v_fmac_f32 v38, v46, v28
    v_fmac_f32 v39, v47, v28
    s_waitcnt vmcnt(2)
    v_lshlrev_b32 v40, 16, v100
    v_and_b32 v41, 0xffff0000, v100
    v_lshlrev_b32 v42, 16, v101
    v_and_b32 v43, 0xffff0000, v101
    v_lshlrev_b32 v44, 16, v102
    v_and_b32 v45, 0xffff0000, v102
    v_lshlrev_b32 v46, 16, v103
    v_and_b32 v47, 0xffff0000, v103
    v_fmac_f32 v32, v40, v29
    v_fmac_f32 v33, v41, v29
    v_fmac_f32 v34, v42, v29
    v_fmac_f32 v35, v43, v29
    v_fmac_f32 v36, v44, v29
    v_fmac_f32 v37, v45, v29
    v_fmac_f32 v38, v46, v29
    v_fmac_f32 v39, v47, v29
    s_waitcnt vmcnt(1)
    v_lshlrev_b32 v40, 16, v104
    v_and_b32 v41, 0xffff0000, v104
    v_lshlrev_b32 v42, 16, v105
    v_and_b32 v43, 0xffff0000, v105
    v_lshlrev_b32 v44, 16, v106
    v_and_b32 v45, 0xffff0000, v106
    v_lshlrev_b32 v46, 16, v107
    v_and_b32 v47, 0xffff0000, v107
    v_fmac_f32 v32, v40, v30
    v_fmac_f32 v33, v41, v30
    v_fmac_f32 v34, v42, v30
    v_fmac_f32 v35, v43, v30
    v_fmac_f32 v36, v44, v30
    v_fmac_f32 v37, v45, v30
    v_fmac_f32 v38, v46, v30
    v_fmac_f32 v39, v47, v30
    s_waitcnt vmcnt(0)
    v_lshlrev_b32 v40, 16, v108
    v_and_b32 v41, 0xffff0000, v108
    v_lshlrev_b32 v42, 16, v109
    v_and_b32 v43, 0xffff0000, v109
    v_lshlrev_b32 v44, 16, v110
    v_and_b32 v45, 0xffff0000, v110
    v_lshlrev_b32 v46, 16, v111
    v_and_b32 v47, 0xffff0000, v111
    v_fmac_f32 v32, v40, v31
    v_fmac_f32 v33, v41, v31
    v_fmac_f32 v34, v42, v31
    v_fmac_f32 v35, v43, v31
    v_fmac_f32 v36, v44, v31
    v_fmac_f32 v37, v45, v31
    v_fmac_f32 v38, v46, v31
    v_fmac_f32 v39, v47, v31
    s_cmp_lg_u32 s2, 0
    s_cbranch_scc1 P_NOZ
    buffer_store_dword v6, v5, s[4:7], s18 offen
P_NOZ:
    v_lshlrev_b32 v5, 5, v0
    v_readfirstlane_b32 s18, v0
    ds_write_b128 v5, v[32:35]
    ds_write_b128 v5, v[36:39] offset:16
    s_waitcnt lgkmcnt(0)
    s_barrier
    s_cmp_lg_u32 s18, 0
    s_cbranch_scc1 P_END
    v_lshlrev_b32 v6, 2, v0
    ds_read_b32 v48, v6 offset:0
    ds_read_b32 v49, v6 offset:256
    ds_read_b32 v50, v6 offset:512
    ds_read_b32 v51, v6 offset:768
    ds_read_b32 v52, v6 offset:1024
    ds_read_b32 v53, v6 offset:1280
    ds_read_b32 v54, v6 offset:1536
    ds_read_b32 v55, v6 offset:1792
    ds_read_b32 v56, v6 offset:2048
    ds_read_b32 v57, v6 offset:2304
    ds_read_b32 v58, v6 offset:2560
    ds_read_b32 v59, v6 offset:2816
    ds_read_b32 v60, v6 offset:3072
    ds_read_b32 v61, v6 offset:3328
    ds_read_b32 v62, v6 offset:3584
    ds_read_b32 v63, v6 offset:3840
    ds_read_b32 v64, v6 offset:4096
    ds_read_b32 v65, v6 offset:4352
    ds_read_b32 v66, v6 offset:4608
    ds_read_b32 v67, v6 offset:4864
    ds_read_b32 v68, v6 offset:5120
    ds_read_b32 v69, v6 offset:5376
    ds_read_b32 v70, v6 offset:5632
    ds_read_b32 v71, v6 offset:5888
    ds_read_b32 v72, v6 offset:6144
    ds_read_b32 v73, v6 offset:6400
    ds_read_b32 v74, v6 offset:6656
    ds_read_b32 v75, v6 offset:6912
    ds_read_b32 v76, v6 offset:7168
    ds_read_b32 v77, v6 offset:7424
    ds_read_b32 v78, v6 offset:7680
    ds_read_b32 v79, v6 offset:7936
    s_waitcnt lgkmcnt(0)
    v_add_f32 v48, v48, v64
    v_add_f32 v49, v49, v65
    v_add_f32 v50, v50, v66
    v_add_f32 v51, v51, v67
    v_add_f32 v52, v52, v68
    v_add_f32 v53, v53, v69
    v_add_f32 v54, v54, v70
    v_add_f32 v55, v55, v71
    v_add_f32 v56, v56, v72
    v_add_f32 v57, v57, v73
    v_add_f32 v58, v58, v74
    v_add_f32 v59, v59, v75
    v_add_f32 v60, v60, v76
    v_add_f32 v61, v61, v77
    v_add_f32 v62, v62, v78
    v_add_f32 v63, v63, v79
    v_add_f32 v48, v48, v56
    v_add_f32 v49, v49, v57
    v_add_f32 v50, v50, v58
    v_add_f32 v51, v51, v59
    v_add_f32 v52, v52, v60
    v_add_f32 v53, v53, v61
    v_add_f32 v54, v54, v62
    v_add_f32 v55, v55, v63
    v_add_f32 v48, v48, v52
    v_add_f32 v49, v49, v53
    v_add_f32 v50, v50, v54
    v_add_f32 v51, v51, v55
    v_add_f32 v48, v48, v50
    v_add_f32 v49, v49, v51
    v_add_f32 v48, v48, v49
    v_cvt_pk_bf16_f32 v48, v48, v48
    v_and_b32 v48, 0xffff0000, v48
    s_lshl_b32 s17, s2, 8
    buffer_store_dword v48, v6, s[4:7], s17 offen sc1
    s_waitcnt vmcnt(0)
    s_mov_b64 exec, 1
    v_mov_b32 v1, 0
    v_mov_b32 v2, 1
    v_mov_b32 v3, 1
    buffer_atomic_add v2, v1, s[56:59], 0 offen sc0 sc1
    s_waitcnt vmcnt(0)
    v_cmp_eq_u32 vcc, 175, v2
    s_cbranch_vccz P_END
    buffer_store_dword v3, v1, s[56:59], 0 offen offset:128 sc1
P_END:
    s_endpgm
P_LN:
    s_load_dwordx2 s[8:9], s[0:1], 0
    s_mov_b32 s10, 0x200000
    s_mov_b32 s11, 0x00020000
    s_sub_u32 s16, s2, 48
    s_and_b32 s17, s16, 7
    s_lshl_b32 s17, s17, 1
    s_bfe_u32 s18, s16, 0x10003
    s_and_b32 s16, s16, 0x70
    s_or_b32 s16, s16, s17
    s_or_b32 s16, s16, s18
    v_lshrrev_b32 v1, 6, v0
    v_and_b32 v2, 63, v0
    v_lshlrev_b32 v3, 12, v1
    v_lshl_add_u32 v3, v2, 4, v3
    s_lshl_b32 s17, s16, 14
    s_waitcnt lgkmcnt(0)
    buffer_load_dwordx4 v[8:11], v3, s[8:11], s17 offen offset:0
    buffer_load_dwordx4 v[12:15], v3, s[8:11], s17 offen offset:1024
    buffer_load_dwordx4 v[16:19], v3, s[8:11], s17 offen offset:2048
    buffer_load_dwordx4 v[20:23], v3, s[8:11], s17 offen offset:3072
    s_waitcnt vmcnt(3)
    v_lshlrev_b32 v32, 16, v8
    v_and_b32 v33, 0xffff0000, v8
    v_lshlrev_b32 v34, 16, v9
    v_and_b32 v35, 0xffff0000, v9
    v_lshlrev_b32 v36, 16, v10
    v_and_b32 v37, 0xffff0000, v10
    v_lshlrev_b32 v38, 16, v11
    v_and_b32 v39, 0xffff0000, v11
    v_add_f32 v24, v32, v33
    v_add_f32 v24, v24, v34
    v_add_f32 v24, v24, v35
    v_add_f32 v24, v24, v36
    v_add_f32 v24, v24, v37
    v_add_f32 v24, v24, v38
    v_add_f32 v24, v24, v39
    s_waitcnt vmcnt(2)
    v_lshlrev_b32 v40, 16, v12
    v_and_b32 v41, 0xffff0000, v12
    v_lshlrev_b32 v42, 16, v13
    v_and_b32 v43, 0xffff0000, v13
    v_lshlrev_b32 v44, 16, v14
    v_and_b32 v45, 0xffff0000, v14
    v_lshlrev_b32 v46, 16, v15
    v_and_b32 v47, 0xffff0000, v15
    v_add_f32 v25, v40, v41
    v_add_f32 v25, v25, v42
    v_add_f32 v25, v25, v43
    v_add_f32 v25, v25, v44
    v_add_f32 v25, v25, v45
    v_add_f32 v25, v25, v46
    v_add_f32 v25, v25, v47
    s_waitcnt vmcnt(1)
    v_lshlrev_b32 v48, 16, v16
    v_and_b32 v49, 0xffff0000, v16
    v_lshlrev_b32 v50, 16, v17
    v_and_b32 v51, 0xffff0000, v17
    v_lshlrev_b32 v52, 16, v18
    v_and_b32 v53, 0xffff0000, v18
    v_lshlrev_b32 v54, 16, v19
    v_and_b32 v55, 0xffff0000, v19
    v_add_f32 v26, v48, v49
    v_add_f32 v26, v26, v50
    v_add_f32 v26, v26, v51
    v_add_f32 v26, v26, v52
    v_add_f32 v26, v26, v53
    v_add_f32 v26, v26, v54
    v_add_f32 v26, v26, v55
    s_waitcnt vmcnt(0)
    v_lshlrev_b32 v56, 16, v20
    v_and_b32 v57, 0xffff0000, v20
    v_lshlrev_b32 v58, 16, v21
    v_and_b32 v59, 0xffff0000, v21
    v_lshlrev_b32 v60, 16, v22
    v_and_b32 v61, 0xffff0000, v22
    v_lshlrev_b32 v62, 16, v23
    v_and_b32 v63, 0xffff0000, v23
    v_add_f32 v27, v56, v57
    v_add_f32 v27, v27, v58
    v_add_f32 v27, v27, v59
    v_add_f32 v27, v27, v60
    v_add_f32 v27, v27, v61
    v_add_f32 v27, v27, v62
    v_add_f32 v27, v27, v63
    s_nop 1
    v_add_f32_dpp v24, v24, v24 row_shr:1 row_mask:0xf bank_mask:0xf bound_ctrl:0
    v_add_f32_dpp v25, v25, v25 row_shr:1 row_mask:0xf bank_mask:0xf bound_ctrl:0
    v_add_f32_dpp v26, v26, v26 row_shr:1 row_mask:0xf bank_mask:0xf bound_ctrl:0
    v_add_f32_dpp v27, v27, v27 row_shr:1 row_mask:0xf bank_mask:0xf bound_ctrl:0
    v_add_f32_dpp v24, v24, v24 row_shr:2 row_mask:0xf bank_mask:0xf bound_ctrl:0
    v_add_f32_dpp v25, v25, v25 row_shr:2 row_mask:0xf bank_mask:0xf bound_ctrl:0
    v_add_f32_dpp v26, v26, v26 row_shr:2 row_mask:0xf bank_mask:0xf bound_ctrl:0
    v_add_f32_dpp v27, v27, v27 row_shr:2 row_mask:0xf bank_mask:0xf bound_ctrl:0
    v_add_f32_dpp v24, v24, v24 row_shr:4 row_mask:0xf bank_mask:0xf bound_ctrl:0
    v_add_f32_dpp v25, v25, v25 row_shr:4 row_mask:0xf bank_mask:0xf bound_ctrl:0
    v_add_f32_dpp v26, v26, v26 row_shr:4 row_mask:0xf bank_mask:0xf bound_ctrl:0
    v_add_f32_dpp v27, v27, v27 row_shr:4 row_mask:0xf bank_mask:0xf bound_ctrl:0
    v_add_f32_dpp v24, v24, v24 row_shr:8 row_mask:0xf bank_mask:0xf bound_ctrl:0
    v_add_f32_dpp v25, v25, v25 row_shr:8 row_mask:0xf bank_mask:0xf bound_ctrl:0
    v_add_f32_dpp v26, v26, v26 row_shr:8 row_mask:0xf bank_mask:0xf bound_ctrl:0
    v_add_f32_dpp v27, v27, v27 row_shr:8 row_mask:0xf bank_mask:0xf bound_ctrl:0
    v_add_f32_dpp v24, v24, v24 row_bcast:15 row_mask:0xa bank_mask:0xf
    v_add_f32_dpp v25, v25, v25 row_bcast:15 row_mask:0xa bank_mask:0xf
    v_add_f32_dpp v26, v26, v26 row_bcast:15 row_mask:0xa bank_mask:0xf
    v_add_f32_dpp v27, v27, v27 row_bcast:15 row_mask:0xa bank_mask:0xf
    v_add_f32_dpp v24, v24, v24 row_bcast:31 row_mask:0xc bank_mask:0xf
    v_add_f32_dpp v25, v25, v25 row_bcast:31 row_mask:0xc bank_mask:0xf
    v_add_f32_dpp v26, v26, v26 row_bcast:31 row_mask:0xc bank_mask:0xf
    v_add_f32_dpp v27, v27, v27 row_bcast:31 row_mask:0xc bank_mask:0xf
    s_nop 1
    v_readlane_b32 s20, v24, 63
    v_readlane_b32 s21, v25, 63
    v_readlane_b32 s22, v26, 63
    v_readlane_b32 s23, v27, 63
    s_nop 1
    v_mov_b32 v24, s20
    v_mov_b32 v25, s21
    v_mov_b32 v26, s22
    v_mov_b32 v27, s23
    v_mul_f32 v24, 0x3b000000, v24
    v_mul_f32 v25, 0x3b000000, v25
    v_mul_f32 v26, 0x3b000000, v26
    v_mul_f32 v27, 0x3b000000, v27
    v_mov_b32 v28, 0
    v_sub_f32 v64, v32, v24
    v_fmac_f32 v28, v64, v64
    v_sub_f32 v64, v33, v24
    v_fmac_f32 v28, v64, v64
    v_sub_f32 v64, v34, v24
    v_fmac_f32 v28, v64, v64
    v_sub_f32 v64, v35, v24
    v_fmac_f32 v28, v64, v64
    v_sub_f32 v64, v36, v24
    v_fmac_f32 v28, v64, v64
    v_sub_f32 v64, v37, v24
    v_fmac_f32 v28, v64, v64
    v_sub_f32 v64, v38, v24
    v_fmac_f32 v28, v64, v64
    v_sub_f32 v64, v39, v24
    v_fmac_f32 v28, v64, v64
    v_mov_b32 v29, 0
    v_sub_f32 v64, v40, v25
    v_fmac_f32 v29, v64, v64
    v_sub_f32 v64, v41, v25
    v_fmac_f32 v29, v64, v64
    v_sub_f32 v64, v42, v25
    v_fmac_f32 v29, v64, v64
    v_sub_f32 v64, v43, v25
    v_fmac_f32 v29, v64, v64
    v_sub_f32 v64, v44, v25
    v_fmac_f32 v29, v64, v64
    v_sub_f32 v64, v45, v25
    v_fmac_f32 v29, v64, v64
    v_sub_f32 v64, v46, v25
    v_fmac_f32 v29, v64, v64
    v_sub_f32 v64, v47, v25
    v_fmac_f32 v29, v64, v64
    v_mov_b32 v30, 0
    v_sub_f32 v64, v48, v26
    v_fmac_f32 v30, v64, v64
    v_sub_f32 v64, v49, v26
    v_fmac_f32 v30, v64, v64
    v_sub_f32 v64, v50, v26
    v_fmac_f32 v30, v64, v64
    v_sub_f32 v64, v51, v26
    v_fmac_f32 v30, v64, v64
    v_sub_f32 v64, v52, v26
    v_fmac_f32 v30, v64, v64
    v_sub_f32 v64, v53, v26
    v_fmac_f32 v30, v64, v64
    v_sub_f32 v64, v54, v26
    v_fmac_f32 v30, v64, v64
    v_sub_f32 v64, v55, v26
    v_fmac_f32 v30, v64, v64
    v_mov_b32 v31, 0
    v_sub_f32 v64, v56, v27
    v_fmac_f32 v31, v64, v64
    v_sub_f32 v64, v57, v27
    v_fmac_f32 v31, v64, v64
    v_sub_f32 v64, v58, v27
    v_fmac_f32 v31, v64, v64
    v_sub_f32 v64, v59, v27
    v_fmac_f32 v31, v64, v64
    v_sub_f32 v64, v60, v27
    v_fmac_f32 v31, v64, v64
    v_sub_f32 v64, v61, v27
    v_fmac_f32 v31, v64, v64
    v_sub_f32 v64, v62, v27
    v_fmac_f32 v31, v64, v64
    v_sub_f32 v64, v63, v27
    v_fmac_f32 v31, v64, v64
    s_nop 1
    v_add_f32_dpp v28, v28, v28 row_shr:1 row_mask:0xf bank_mask:0xf bound_ctrl:0
    v_add_f32_dpp v29, v29, v29 row_shr:1 row_mask:0xf bank_mask:0xf bound_ctrl:0
    v_add_f32_dpp v30, v30, v30 row_shr:1 row_mask:0xf bank_mask:0xf bound_ctrl:0
    v_add_f32_dpp v31, v31, v31 row_shr:1 row_mask:0xf bank_mask:0xf bound_ctrl:0
    v_add_f32_dpp v28, v28, v28 row_shr:2 row_mask:0xf bank_mask:0xf bound_ctrl:0
    v_add_f32_dpp v29, v29, v29 row_shr:2 row_mask:0xf bank_mask:0xf bound_ctrl:0
    v_add_f32_dpp v30, v30, v30 row_shr:2 row_mask:0xf bank_mask:0xf bound_ctrl:0
    v_add_f32_dpp v31, v31, v31 row_shr:2 row_mask:0xf bank_mask:0xf bound_ctrl:0
    v_add_f32_dpp v28, v28, v28 row_shr:4 row_mask:0xf bank_mask:0xf bound_ctrl:0
    v_add_f32_dpp v29, v29, v29 row_shr:4 row_mask:0xf bank_mask:0xf bound_ctrl:0
    v_add_f32_dpp v30, v30, v30 row_shr:4 row_mask:0xf bank_mask:0xf bound_ctrl:0
    v_add_f32_dpp v31, v31, v31 row_shr:4 row_mask:0xf bank_mask:0xf bound_ctrl:0
    v_add_f32_dpp v28, v28, v28 row_shr:8 row_mask:0xf bank_mask:0xf bound_ctrl:0
    v_add_f32_dpp v29, v29, v29 row_shr:8 row_mask:0xf bank_mask:0xf bound_ctrl:0
    v_add_f32_dpp v30, v30, v30 row_shr:8 row_mask:0xf bank_mask:0xf bound_ctrl:0
    v_add_f32_dpp v31, v31, v31 row_shr:8 row_mask:0xf bank_mask:0xf bound_ctrl:0
    v_add_f32_dpp v28, v28, v28 row_bcast:15 row_mask:0xa bank_mask:0xf
    v_add_f32_dpp v29, v29, v29 row_bcast:15 row_mask:0xa bank_mask:0xf
    v_add_f32_dpp v30, v30, v30 row_bcast:15 row_mask:0xa bank_mask:0xf
    v_add_f32_dpp v31, v31, v31 row_bcast:15 row_mask:0xa bank_mask:0xf
    v_add_f32_dpp v28, v28, v28 row_bcast:31 row_mask:0xc bank_mask:0xf
    v_add_f32_dpp v29, v29, v29 row_bcast:31 row_mask:0xc bank_mask:0xf
    v_add_f32_dpp v30, v30, v30 row_bcast:31 row_mask:0xc bank_mask:0xf
    v_add_f32_dpp v31, v31, v31 row_bcast:31 row_mask:0xc bank_mask:0xf
    s_nop 1
    v_readlane_b32 s20, v28, 63
    v_readlane_b32 s21, v29, 63
    v_readlane_b32 s22, v30, 63
    v_readlane_b32 s23, v31, 63
    s_nop 1
    v_mov_b32 v28, s20
    v_mov_b32 v29, s21
    v_mov_b32 v30, s22
    v_mov_b32 v31, s23
    v_mul_f32 v28, 0x3b000000, v28
    v_mul_f32 v29, 0x3b000000, v29
    v_mul_f32 v30, 0x3b000000, v30
    v_mul_f32 v31, 0x3b000000, v31
    v_cvt_pk_bf16_f32 v28, v28, v28
    v_and_b32 v28, 0xffff0000, v28
    v_cvt_pk_bf16_f32 v24, v24, v24
    v_and_b32 v24, 0xffff0000, v24
    v_cvt_pk_bf16_f32 v29, v29, v29
    v_and_b32 v29, 0xffff0000, v29
    v_cvt_pk_bf16_f32 v25, v25, v25
    v_and_b32 v25, 0xffff0000, v25
    v_cvt_pk_bf16_f32 v30, v30, v30
    v_and_b32 v30, 0xffff0000, v30
    v_cvt_pk_bf16_f32 v26, v26, v26
    v_and_b32 v26, 0xffff0000, v26
    v_cvt_pk_bf16_f32 v31, v31, v31
    v_and_b32 v31, 0xffff0000, v31
    v_cvt_pk_bf16_f32 v27, v27, v27
    v_and_b32 v27, 0xffff0000, v27
    v_add_f32 v28, 0x3727c5ac, v28
    v_add_f32 v29, 0x3727c5ac, v29
    v_add_f32 v30, 0x3727c5ac, v30
    v_add_f32 v31, 0x3727c5ac, v31
    v_cvt_pk_bf16_f32 v28, v28, v28
    v_and_b32 v28, 0xffff0000, v28
    v_cvt_pk_bf16_f32 v29, v29, v29
    v_and_b32 v29, 0xffff0000, v29
    v_cvt_pk_bf16_f32 v30, v30, v30
    v_and_b32 v30, 0xffff0000, v30
    v_cvt_pk_bf16_f32 v31, v31, v31
    v_and_b32 v31, 0xffff0000, v31
    v_sqrt_f32 v28, v28
    v_sqrt_f32 v29, v29
    v_sqrt_f32 v30, v30
    v_sqrt_f32 v31, v31
    v_cvt_pk_bf16_f32 v28, v28, v28
    v_and_b32 v28, 0xffff0000, v28
    v_cvt_pk_bf16_f32 v29, v29, v29
    v_and_b32 v29, 0xffff0000, v29
    v_cvt_pk_bf16_f32 v30, v30, v30
    v_and_b32 v30, 0xffff0000, v30
    v_cvt_pk_bf16_f32 v31, v31, v31
    v_and_b32 v31, 0xffff0000, v31
    v_rcp_f32 v28, v28
    v_rcp_f32 v29, v29
    v_rcp_f32 v30, v30
    v_rcp_f32 v31, v31
    s_nop 0
    v_sub_f32 v64, v32, v24
    v_sub_f32 v65, v33, v24
    v_cvt_pk_bf16_f32 v66, v64, v65
    v_lshlrev_b32 v64, 16, v66
    v_and_b32 v65, 0xffff0000, v66
    v_mul_f32 v64, v64, v28
    v_mul_f32 v65, v65, v28
    v_cvt_pk_bf16_f32 v72, v64, v32
    v_cvt_pk_bf16_f32 v76, v65, v33
    v_sub_f32 v64, v34, v24
    v_sub_f32 v65, v35, v24
    v_cvt_pk_bf16_f32 v66, v64, v65
    v_lshlrev_b32 v64, 16, v66
    v_and_b32 v65, 0xffff0000, v66
    v_mul_f32 v64, v64, v28
    v_mul_f32 v65, v65, v28
    v_cvt_pk_bf16_f32 v80, v64, v34
    v_cvt_pk_bf16_f32 v84, v65, v35
    v_sub_f32 v64, v36, v24
    v_sub_f32 v65, v37, v24
    v_cvt_pk_bf16_f32 v66, v64, v65
    v_lshlrev_b32 v64, 16, v66
    v_and_b32 v65, 0xffff0000, v66
    v_mul_f32 v64, v64, v28
    v_mul_f32 v65, v65, v28
    v_cvt_pk_bf16_f32 v88, v64, v36
    v_cvt_pk_bf16_f32 v92, v65, v37
    v_sub_f32 v64, v38, v24
    v_sub_f32 v65, v39, v24
    v_cvt_pk_bf16_f32 v66, v64, v65
    v_lshlrev_b32 v64, 16, v66
    v_and_b32 v65, 0xffff0000, v66
    v_mul_f32 v64, v64, v28
    v_mul_f32 v65, v65, v28
    v_cvt_pk_bf16_f32 v96, v64, v38
    v_cvt_pk_bf16_f32 v100, v65, v39
    v_sub_f32 v64, v40, v25
    v_sub_f32 v65, v41, v25
    v_cvt_pk_bf16_f32 v66, v64, v65
    v_lshlrev_b32 v64, 16, v66
    v_and_b32 v65, 0xffff0000, v66
    v_mul_f32 v64, v64, v29
    v_mul_f32 v65, v65, v29
    v_cvt_pk_bf16_f32 v73, v64, v40
    v_cvt_pk_bf16_f32 v77, v65, v41
    v_sub_f32 v64, v42, v25
    v_sub_f32 v65, v43, v25
    v_cvt_pk_bf16_f32 v66, v64, v65
    v_lshlrev_b32 v64, 16, v66
    v_and_b32 v65, 0xffff0000, v66
    v_mul_f32 v64, v64, v29
    v_mul_f32 v65, v65, v29
    v_cvt_pk_bf16_f32 v81, v64, v42
    v_cvt_pk_bf16_f32 v85, v65, v43
    v_sub_f32 v64, v44, v25
    v_sub_f32 v65, v45, v25
    v_cvt_pk_bf16_f32 v66, v64, v65
    v_lshlrev_b32 v64, 16, v66
    v_and_b32 v65, 0xffff0000, v66
    v_mul_f32 v64, v64, v29
    v_mul_f32 v65, v65, v29
    v_cvt_pk_bf16_f32 v89, v64, v44
    v_cvt_pk_bf16_f32 v93, v65, v45
    v_sub_f32 v64, v46, v25
    v_sub_f32 v65, v47, v25
    v_cvt_pk_bf16_f32 v66, v64, v65
    v_lshlrev_b32 v64, 16, v66
    v_and_b32 v65, 0xffff0000, v66
    v_mul_f32 v64, v64, v29
    v_mul_f32 v65, v65, v29
    v_cvt_pk_bf16_f32 v97, v64, v46
    v_cvt_pk_bf16_f32 v101, v65, v47
    v_sub_f32 v64, v48, v26
    v_sub_f32 v65, v49, v26
    v_cvt_pk_bf16_f32 v66, v64, v65
    v_lshlrev_b32 v64, 16, v66
    v_and_b32 v65, 0xffff0000, v66
    v_mul_f32 v64, v64, v30
    v_mul_f32 v65, v65, v30
    v_cvt_pk_bf16_f32 v74, v64, v48
    v_cvt_pk_bf16_f32 v78, v65, v49
    v_sub_f32 v64, v50, v26
    v_sub_f32 v65, v51, v26
    v_cvt_pk_bf16_f32 v66, v64, v65
    v_lshlrev_b32 v64, 16, v66
    v_and_b32 v65, 0xffff0000, v66
    v_mul_f32 v64, v64, v30
    v_mul_f32 v65, v65, v30
    v_cvt_pk_bf16_f32 v82, v64, v50
    v_cvt_pk_bf16_f32 v86, v65, v51
    v_sub_f32 v64, v52, v26
    v_sub_f32 v65, v53, v26
    v_cvt_pk_bf16_f32 v66, v64, v65
    v_lshlrev_b32 v64, 16, v66
    v_and_b32 v65, 0xffff0000, v66
    v_mul_f32 v64, v64, v30
    v_mul_f32 v65, v65, v30
    v_cvt_pk_bf16_f32 v90, v64, v52
    v_cvt_pk_bf16_f32 v94, v65, v53
    v_sub_f32 v64, v54, v26
    v_sub_f32 v65, v55, v26
    v_cvt_pk_bf16_f32 v66, v64, v65
    v_lshlrev_b32 v64, 16, v66
    v_and_b32 v65, 0xffff0000, v66
    v_mul_f32 v64, v64, v30
    v_mul_f32 v65, v65, v30
    v_cvt_pk_bf16_f32 v98, v64, v54
    v_cvt_pk_bf16_f32 v102, v65, v55
    v_sub_f32 v64, v56, v27
    v_sub_f32 v65, v57, v27
    v_cvt_pk_bf16_f32 v66, v64, v65
    v_lshlrev_b32 v64, 16, v66
    v_and_b32 v65, 0xffff0000, v66
    v_mul_f32 v64, v64, v31
    v_mul_f32 v65, v65, v31
    v_cvt_pk_bf16_f32 v75, v64, v56
    v_cvt_pk_bf16_f32 v79, v65, v57
    v_sub_f32 v64, v58, v27
    v_sub_f32 v65, v59, v27
    v_cvt_pk_bf16_f32 v66, v64, v65
    v_lshlrev_b32 v64, 16, v66
    v_and_b32 v65, 0xffff0000, v66
    v_mul_f32 v64, v64, v31
    v_mul_f32 v65, v65, v31
    v_cvt_pk_bf16_f32 v83, v64, v58
    v_cvt_pk_bf16_f32 v87, v65, v59
    v_sub_f32 v64, v60, v27
    v_sub_f32 v65, v61, v27
    v_cvt_pk_bf16_f32 v66, v64, v65
    v_lshlrev_b32 v64, 16, v66
    v_and_b32 v65, 0xffff0000, v66
    v_mul_f32 v64, v64, v31
    v_mul_f32 v65, v65, v31
    v_cvt_pk_bf16_f32 v91, v64, v60
    v_cvt_pk_bf16_f32 v95, v65, v61
    v_sub_f32 v64, v62, v27
    v_sub_f32 v65, v63, v27
    v_cvt_pk_bf16_f32 v66, v64, v65
    v_lshlrev_b32 v64, 16, v66
    v_and_b32 v65, 0xffff0000, v66
    v_mul_f32 v64, v64, v31
    v_mul_f32 v65, v65, v31
    v_cvt_pk_bf16_f32 v99, v64, v62
    v_cvt_pk_bf16_f32 v103, v65, v63
    v_mul_u32_u24 v4, 528, v2
    v_lshl_add_u32 v4, v1, 4, v4
    ds_write_b128 v4, v[72:75] offset:0
    ds_write_b128 v4, v[76:79] offset:64
    ds_write_b128 v4, v[80:83] offset:128
    ds_write_b128 v4, v[84:87] offset:192
    ds_write_b128 v4, v[88:91] offset:256
    ds_write_b128 v4, v[92:95] offset:320
    ds_write_b128 v4, v[96:99] offset:384
    ds_write_b128 v4, v[100:103] offset:448
    s_waitcnt lgkmcnt(0)
    s_barrier
    v_and_b32 v5, 3, v0
    v_lshrrev_b32 v6, 2, v0
    v_lshrrev_b32 v7, 3, v6
    v_mul_u32_u24 v7, 528, v7
    v_and_b32 v4, 7, v6
    v_lshl_add_u32 v7, v4, 6, v7
    v_lshl_add_u32 v7, v5, 4, v7
    ds_read_b128 v[72:75], v7 offset:0
    ds_read_b128 v[76:79], v7 offset:4224
    ds_read_b128 v[80:83], v7 offset:8448
    ds_read_b128 v[84:87], v7 offset:12672
    ds_read_b128 v[88:91], v7 offset:16896
    ds_read_b128 v[92:95], v7 offset:21120
    ds_read_b128 v[96:99], v7 offset:25344
    ds_read_b128 v[100:103], v7 offset:29568
    v_lshlrev_b32 v6, 13, v6
    v_lshl_add_u32 v6, v5, 4, v6
    s_lshl_b32 s17, s16, 6
    s_add_u32 s17, s17, 0x600000
    s_waitcnt lgkmcnt(7)
    buffer_store_dwordx4 v[72:75], v6, s[4:7], s17 offen sc1
    s_add_u32 s17, s17, 0x80000
    s_waitcnt lgkmcnt(6)
    buffer_store_dwordx4 v[76:79], v6, s[4:7], s17 offen sc1
    s_add_u32 s17, s17, 0x80000
    s_waitcnt lgkmcnt(5)
    buffer_store_dwordx4 v[80:83], v6, s[4:7], s17 offen sc1
    s_add_u32 s17, s17, 0x80000
    s_waitcnt lgkmcnt(4)
    buffer_store_dwordx4 v[84:87], v6, s[4:7], s17 offen sc1
    s_add_u32 s17, s17, 0x80000
    s_waitcnt lgkmcnt(3)
    buffer_store_dwordx4 v[88:91], v6, s[4:7], s17 offen sc1
    s_add_u32 s17, s17, 0x80000
    s_waitcnt lgkmcnt(2)
    buffer_store_dwordx4 v[92:95], v6, s[4:7], s17 offen sc1
    s_add_u32 s17, s17, 0x80000
    s_waitcnt lgkmcnt(1)
    buffer_store_dwordx4 v[96:99], v6, s[4:7], s17 offen sc1
    s_add_u32 s17, s17, 0x80000
    s_waitcnt lgkmcnt(0)
    buffer_store_dwordx4 v[100:103], v6, s[4:7], s17 offen sc1
    s_add_u32 s17, s17, 0x80000
    v_readfirstlane_b32 s18, v0
    s_waitcnt vmcnt(0)
    s_barrier
    s_cmp_lg_u32 s18, 0
    s_cbranch_scc1 P_END
    s_mov_b64 exec, 1
    v_mov_b32 v1, 0
    v_mov_b32 v2, 1
    v_mov_b32 v3, 1
    buffer_atomic_add v2, v1, s[56:59], 0 offen sc0 sc1
    s_waitcnt vmcnt(0)
    v_cmp_eq_u32 vcc, 175, v2
    s_cbranch_vccz P_END
    buffer_store_dword v3, v1, s[56:59], 0 offen offset:128 sc1
    s_endpgm
P_W2:
    s_load_dwordx2 s[8:9], s[0:1], 96
    s_mov_b32 s10, 0x1c0000
    s_mov_b32 s11, 0x00020000
    s_sub_u32 s16, s2, 176
    v_lshrrev_b32 v1, 6, v0
    v_and_b32 v2, 63, v0
    v_lshrrev_b32 v3, 1, v1
    v_and_b32 v4, 1, v1
    v_lshlrev_b32 v5, 14, v3
    v_lshl_add_u32 v5, v4, 12, v5
    v_lshl_add_u32 v5, v2, 4, v5
    s_lshl_b32 s17, s16, 15
    s_add_u32 s18, s17, 8192
    s_mov_b32 s20, 0x05040100
    s_mov_b32 s21, 0x07060302
    s_waitcnt lgkmcnt(0)
    buffer_load_dwordx4 v[8:11], v5, s[8:11], s17 offen offset:0
    buffer_load_dwordx4 v[12:15], v5, s[8:11], s17 offen offset:1024
    buffer_load_dwordx4 v[16:19], v5, s[8:11], s17 offen offset:2048
    buffer_load_dwordx4 v[20:23], v5, s[8:11], s17 offen offset:3072
    buffer_load_dwordx4 v[24:27], v5, s[8:11], s18 offen offset:0
    buffer_load_dwordx4 v[28:31], v5, s[8:11], s18 offen offset:1024
    buffer_load_dwordx4 v[32:35], v5, s[8:11], s18 offen offset:2048
    buffer_load_dwordx4 v[36:39], v5, s[8:11], s18 offen offset:3072
    v_mul_u32_u24 v6, 144, v0
    s_lshl_b32 s17, s16, 11
    s_add_u32 s17, s17, 0x3d0000
    s_waitcnt vmcnt(0)
    v_perm_b32 v40, v12, v8, s20
    v_perm_b32 v41, v20, v16, s20
    v_perm_b32 v42, v28, v24, s20
    v_perm_b32 v43, v36, v32, s20
    ds_write_b128 v6, v[40:43] offset:0
    v_perm_b32 v44, v12, v8, s21
    v_perm_b32 v45, v20, v16, s21
    v_perm_b32 v46, v28, v24, s21
    v_perm_b32 v47, v36, v32, s21
    ds_write_b128 v6, v[44:47] offset:16
    v_perm_b32 v48, v13, v9, s20
    v_perm_b32 v49, v21, v17, s20
    v_perm_b32 v50, v29, v25, s20
    v_perm_b32 v51, v37, v33, s20
    ds_write_b128 v6, v[48:51] offset:32
    v_perm_b32 v52, v13, v9, s21
    v_perm_b32 v53, v21, v17, s21
    v_perm_b32 v54, v29, v25, s21
    v_perm_b32 v55, v37, v33, s21
    ds_write_b128 v6, v[52:55] offset:48
    v_perm_b32 v56, v14, v10, s20
    v_perm_b32 v57, v22, v18, s20
    v_perm_b32 v58, v30, v26, s20
    v_perm_b32 v59, v38, v34, s20
    ds_write_b128 v6, v[56:59] offset:64
    v_perm_b32 v60, v14, v10, s21
    v_perm_b32 v61, v22, v18, s21
    v_perm_b32 v62, v30, v26, s21
    v_perm_b32 v63, v38, v34, s21
    ds_write_b128 v6, v[60:63] offset:80
    v_perm_b32 v64, v15, v11, s20
    v_perm_b32 v65, v23, v19, s20
    v_perm_b32 v66, v31, v27, s20
    v_perm_b32 v67, v39, v35, s20
    ds_write_b128 v6, v[64:67] offset:96
    v_perm_b32 v68, v15, v11, s21
    v_perm_b32 v69, v23, v19, s21
    v_perm_b32 v70, v31, v27, s21
    v_perm_b32 v71, v39, v35, s21
    ds_write_b128 v6, v[68:71] offset:112
    s_waitcnt lgkmcnt(0)
    v_lshrrev_b32 v56, 6, v0
    v_and_b32 v57, 63, v0
    v_mul_u32_u24 v58, 9216, v56
    v_lshrrev_b32 v59, 3, v57
    v_mul_u32_u24 v59, 144, v59
    v_add_u32 v58, v58, v59
    v_and_b32 v59, 7, v57
    v_lshl_add_u32 v58, v59, 4, v58
    s_waitcnt lgkmcnt(0)
    ds_read_b128 v[64:67], v58 offset:0
    ds_read_b128 v[68:71], v58 offset:1152
    ds_read_b128 v[72:75], v58 offset:2304
    ds_read_b128 v[76:79], v58 offset:3456
    ds_read_b128 v[80:83], v58 offset:4608
    ds_read_b128 v[84:87], v58 offset:5760
    ds_read_b128 v[88:91], v58 offset:6912
    ds_read_b128 v[92:95], v58 offset:8064
    v_lshrrev_b32 v59, 5, v57
    v_mul_u32_u24 v59, 114688, v59
    v_lshl_add_u32 v59, v56, 9, v59
    v_and_b32 v57, 31, v57
    v_lshl_add_u32 v59, v57, 4, v59
    s_waitcnt lgkmcnt(7)
    buffer_store_dwordx4 v[64:67], v59, s[4:7], s17 offen
    s_add_u32 s17, s17, 229376
    s_waitcnt lgkmcnt(6)
    buffer_store_dwordx4 v[68:71], v59, s[4:7], s17 offen
    s_add_u32 s17, s17, 229376
    s_waitcnt lgkmcnt(5)
    buffer_store_dwordx4 v[72:75], v59, s[4:7], s17 offen
    s_add_u32 s17, s17, 229376
    s_waitcnt lgkmcnt(4)
    buffer_store_dwordx4 v[76:79], v59, s[4:7], s17 offen
    s_add_u32 s17, s17, 229376
    s_waitcnt lgkmcnt(3)
    buffer_store_dwordx4 v[80:83], v59, s[4:7], s17 offen
    s_add_u32 s17, s17, 229376
    s_waitcnt lgkmcnt(2)
    buffer_store_dwordx4 v[84:87], v59, s[4:7], s17 offen
    s_add_u32 s17, s17, 229376
    s_waitcnt lgkmcnt(1)
    buffer_store_dwordx4 v[88:91], v59, s[4:7], s17 offen
    s_add_u32 s17, s17, 229376
    s_waitcnt lgkmcnt(0)
    buffer_store_dwordx4 v[92:95], v59, s[4:7], s17 offen
    s_add_u32 s17, s17, 229376
    s_load_dwordx2 s[8:9], s[0:1], 80
    s_mov_b32 s10, 0x1c0000
    s_mov_b32 s11, 0x00020000
    s_load_dwordx2 s[12:13], s[0:1], 88
    s_mov_b32 s14, 0xe00
    s_mov_b32 s15, 0x00020000
    v_and_b32 v1, 3, v0
    v_lshrrev_b32 v2, 2, v0
    v_mul_u32_u24 v3, 28672, v2
    v_lshl_add_u32 v3, v1, 4, v3
    s_lshl_b32 s17, s16, 6
    v_lshlrev_b32 v4, 5, v2
    s_waitcnt lgkmcnt(0)
    s_mov_b32 s18, 8192
    s_mov_b32 s19, 6144
    buffer_load_dwordx4 v[24:27], v3, s[8:11], s17 offen
    s_add_u32 s17, s17, 3584
    buffer_load_dwordx4 v[28:31], v3, s[8:11], s17 offen
    s_add_u32 s17, s17, 3584
    buffer_load_dwordx4 v[32:35], v3, s[8:11], s17 offen
    s_add_u32 s17, s17, 3584
    buffer_load_dwordx4 v[36:39], v3, s[8:11], s17 offen
    s_add_u32 s17, s17, 3584
    buffer_load_dwordx4 v[40:43], v3, s[8:11], s17 offen
    s_add_u32 s17, s17, 3584
    buffer_load_dwordx4 v[44:47], v3, s[8:11], s17 offen
    s_add_u32 s17, s17, 3584
    buffer_load_dwordx4 v[48:51], v3, s[8:11], s17 offen
    s_add_u32 s17, s17, 3584
    buffer_load_dwordx4 v[52:55], v3, s[8:11], s17 offen
    s_add_u32 s17, s17, 3584
    v_and_b32 v5, 31, v0
    v_lshlrev_b32 v5, 1, v5
    s_lshl_b32 s17, s16, 6
    buffer_load_ushort v7, v5, s[12:15], s17 offen
    v_mov_b32 v8, 0
    s_mov_b32 s38, 0x40000
W_POLL:
    buffer_load_dword v9, v8, s[56:59], 0 offen offset:128 sc1
    s_waitcnt vmcnt(0)
    v_cmp_ne_u32 vcc, 1, v9
    s_cbranch_vccz W_PD
    s_sleep 2
    s_sub_u32 s38, s38, 1
    s_cmp_lg_u32 s38, 0
    s_cbranch_scc1 W_POLL
W_PD:
    buffer_load_dwordx4 v[8:11], v4, s[4:7], s18 offen sc1
    buffer_load_dwordx4 v[12:15], v4, s[4:7], s18 offen offset:16 sc1
    buffer_load_dwordx4 v[16:19], v4, s[4:7], s19 offen sc1
    buffer_load_dwordx4 v[20:23], v4, s[4:7], s19 offen offset:16 sc1
    v_mul_u32_u24 v6, 144, v0
    s_lshl_b32 s17, s16, 15
    s_add_u32 s17, s17, 0x210000
    s_mov_b32 s20, 0x3f803f80
    s_waitcnt vmcnt(2)
    v_add_f32 v8, 1.0, v8
    v_add_f32 v9, 1.0, v9
    v_add_f32 v10, 1.0, v10
    v_add_f32 v11, 1.0, v11
    v_add_f32 v12, 1.0, v12
    v_add_f32 v13, 1.0, v13
    v_add_f32 v14, 1.0, v14
    v_add_f32 v15, 1.0, v15
    v_cvt_pk_bf16_f32 v8, v8, v8
    v_and_b32 v8, 0xffff0000, v8
    v_cvt_pk_bf16_f32 v9, v9, v9
    v_and_b32 v9, 0xffff0000, v9
    v_cvt_pk_bf16_f32 v10, v10, v10
    v_and_b32 v10, 0xffff0000, v10
    v_cvt_pk_bf16_f32 v11, v11, v11
    v_and_b32 v11, 0xffff0000, v11
    v_cvt_pk_bf16_f32 v12, v12, v12
    v_and_b32 v12, 0xffff0000, v12
    v_cvt_pk_bf16_f32 v13, v13, v13
    v_and_b32 v13, 0xffff0000, v13
    v_cvt_pk_bf16_f32 v14, v14, v14
    v_and_b32 v14, 0xffff0000, v14
    v_cvt_pk_bf16_f32 v15, v15, v15
    v_and_b32 v15, 0xffff0000, v15
    v_mov_b32 v96, 0
    v_mov_b32 v97, 0
    v_mov_b32 v98, 0
    v_mov_b32 v99, 0
    v_mov_b32 v100, 0
    v_mov_b32 v101, 0
    v_mov_b32 v102, 0
    v_mov_b32 v103, 0
    v_mov_b32 v104, 0
    v_mov_b32 v105, 0
    v_mov_b32 v106, 0
    v_mov_b32 v107, 0
    v_mov_b32 v108, 0
    v_mov_b32 v109, 0
    v_mov_b32 v110, 0
    v_mov_b32 v111, 0
    s_waitcnt vmcnt(0)
    v_lshlrev_b32 v56, 16, v24
    v_lshlrev_b32 v57, 16, v28
    v_lshlrev_b32 v58, 16, v32
    v_lshlrev_b32 v59, 16, v36
    v_lshlrev_b32 v60, 16, v40
    v_lshlrev_b32 v61, 16, v44
    v_lshlrev_b32 v62, 16, v48
    v_lshlrev_b32 v63, 16, v52
    v_fmac_f32 v104, v56, v16
    v_fmac_f32 v104, v57, v17
    v_fmac_f32 v104, v58, v18
    v_fmac_f32 v104, v59, v19
    v_fmac_f32 v104, v60, v20
    v_fmac_f32 v104, v61, v21
    v_fmac_f32 v104, v62, v22
    v_fmac_f32 v104, v63, v23
    v_mul_f32 v56, v56, v8
    v_mul_f32 v57, v57, v9
    v_mul_f32 v58, v58, v10
    v_mul_f32 v59, v59, v11
    v_mul_f32 v60, v60, v12
    v_mul_f32 v61, v61, v13
    v_mul_f32 v62, v62, v14
    v_mul_f32 v63, v63, v15
    v_cvt_pk_bf16_f32 v64, v56, v57
    v_cvt_pk_bf16_f32 v65, v58, v59
    v_cvt_pk_bf16_f32 v66, v60, v61
    v_cvt_pk_bf16_f32 v67, v62, v63
    ds_write_b128 v6, v[64:67] offset:0
    v_dot2_f32_bf16 v96, v64, s20, v96
    v_dot2_f32_bf16 v96, v65, s20, v96
    v_dot2_f32_bf16 v96, v66, s20, v96
    v_dot2_f32_bf16 v96, v67, s20, v96
    v_and_b32 v56, 0xffff0000, v24
    v_and_b32 v57, 0xffff0000, v28
    v_and_b32 v58, 0xffff0000, v32
    v_and_b32 v59, 0xffff0000, v36
    v_and_b32 v60, 0xffff0000, v40
    v_and_b32 v61, 0xffff0000, v44
    v_and_b32 v62, 0xffff0000, v48
    v_and_b32 v63, 0xffff0000, v52
    v_fmac_f32 v105, v56, v16
    v_fmac_f32 v105, v57, v17
    v_fmac_f32 v105, v58, v18
    v_fmac_f32 v105, v59, v19
    v_fmac_f32 v105, v60, v20
    v_fmac_f32 v105, v61, v21
    v_fmac_f32 v105, v62, v22
    v_fmac_f32 v105, v63, v23
    v_mul_f32 v56, v56, v8
    v_mul_f32 v57, v57, v9
    v_mul_f32 v58, v58, v10
    v_mul_f32 v59, v59, v11
    v_mul_f32 v60, v60, v12
    v_mul_f32 v61, v61, v13
    v_mul_f32 v62, v62, v14
    v_mul_f32 v63, v63, v15
    v_cvt_pk_bf16_f32 v68, v56, v57
    v_cvt_pk_bf16_f32 v69, v58, v59
    v_cvt_pk_bf16_f32 v70, v60, v61
    v_cvt_pk_bf16_f32 v71, v62, v63
    ds_write_b128 v6, v[68:71] offset:16
    v_dot2_f32_bf16 v97, v68, s20, v97
    v_dot2_f32_bf16 v97, v69, s20, v97
    v_dot2_f32_bf16 v97, v70, s20, v97
    v_dot2_f32_bf16 v97, v71, s20, v97
    v_lshlrev_b32 v56, 16, v25
    v_lshlrev_b32 v57, 16, v29
    v_lshlrev_b32 v58, 16, v33
    v_lshlrev_b32 v59, 16, v37
    v_lshlrev_b32 v60, 16, v41
    v_lshlrev_b32 v61, 16, v45
    v_lshlrev_b32 v62, 16, v49
    v_lshlrev_b32 v63, 16, v53
    v_fmac_f32 v106, v56, v16
    v_fmac_f32 v106, v57, v17
    v_fmac_f32 v106, v58, v18
    v_fmac_f32 v106, v59, v19
    v_fmac_f32 v106, v60, v20
    v_fmac_f32 v106, v61, v21
    v_fmac_f32 v106, v62, v22
    v_fmac_f32 v106, v63, v23
    v_mul_f32 v56, v56, v8
    v_mul_f32 v57, v57, v9
    v_mul_f32 v58, v58, v10
    v_mul_f32 v59, v59, v11
    v_mul_f32 v60, v60, v12
    v_mul_f32 v61, v61, v13
    v_mul_f32 v62, v62, v14
    v_mul_f32 v63, v63, v15
    v_cvt_pk_bf16_f32 v72, v56, v57
    v_cvt_pk_bf16_f32 v73, v58, v59
    v_cvt_pk_bf16_f32 v74, v60, v61
    v_cvt_pk_bf16_f32 v75, v62, v63
    ds_write_b128 v6, v[72:75] offset:32
    v_dot2_f32_bf16 v98, v72, s20, v98
    v_dot2_f32_bf16 v98, v73, s20, v98
    v_dot2_f32_bf16 v98, v74, s20, v98
    v_dot2_f32_bf16 v98, v75, s20, v98
    v_and_b32 v56, 0xffff0000, v25
    v_and_b32 v57, 0xffff0000, v29
    v_and_b32 v58, 0xffff0000, v33
    v_and_b32 v59, 0xffff0000, v37
    v_and_b32 v60, 0xffff0000, v41
    v_and_b32 v61, 0xffff0000, v45
    v_and_b32 v62, 0xffff0000, v49
    v_and_b32 v63, 0xffff0000, v53
    v_fmac_f32 v107, v56, v16
    v_fmac_f32 v107, v57, v17
    v_fmac_f32 v107, v58, v18
    v_fmac_f32 v107, v59, v19
    v_fmac_f32 v107, v60, v20
    v_fmac_f32 v107, v61, v21
    v_fmac_f32 v107, v62, v22
    v_fmac_f32 v107, v63, v23
    v_mul_f32 v56, v56, v8
    v_mul_f32 v57, v57, v9
    v_mul_f32 v58, v58, v10
    v_mul_f32 v59, v59, v11
    v_mul_f32 v60, v60, v12
    v_mul_f32 v61, v61, v13
    v_mul_f32 v62, v62, v14
    v_mul_f32 v63, v63, v15
    v_cvt_pk_bf16_f32 v76, v56, v57
    v_cvt_pk_bf16_f32 v77, v58, v59
    v_cvt_pk_bf16_f32 v78, v60, v61
    v_cvt_pk_bf16_f32 v79, v62, v63
    ds_write_b128 v6, v[76:79] offset:48
    v_dot2_f32_bf16 v99, v76, s20, v99
    v_dot2_f32_bf16 v99, v77, s20, v99
    v_dot2_f32_bf16 v99, v78, s20, v99
    v_dot2_f32_bf16 v99, v79, s20, v99
    v_lshlrev_b32 v56, 16, v26
    v_lshlrev_b32 v57, 16, v30
    v_lshlrev_b32 v58, 16, v34
    v_lshlrev_b32 v59, 16, v38
    v_lshlrev_b32 v60, 16, v42
    v_lshlrev_b32 v61, 16, v46
    v_lshlrev_b32 v62, 16, v50
    v_lshlrev_b32 v63, 16, v54
    v_fmac_f32 v108, v56, v16
    v_fmac_f32 v108, v57, v17
    v_fmac_f32 v108, v58, v18
    v_fmac_f32 v108, v59, v19
    v_fmac_f32 v108, v60, v20
    v_fmac_f32 v108, v61, v21
    v_fmac_f32 v108, v62, v22
    v_fmac_f32 v108, v63, v23
    v_mul_f32 v56, v56, v8
    v_mul_f32 v57, v57, v9
    v_mul_f32 v58, v58, v10
    v_mul_f32 v59, v59, v11
    v_mul_f32 v60, v60, v12
    v_mul_f32 v61, v61, v13
    v_mul_f32 v62, v62, v14
    v_mul_f32 v63, v63, v15
    v_cvt_pk_bf16_f32 v80, v56, v57
    v_cvt_pk_bf16_f32 v81, v58, v59
    v_cvt_pk_bf16_f32 v82, v60, v61
    v_cvt_pk_bf16_f32 v83, v62, v63
    ds_write_b128 v6, v[80:83] offset:64
    v_dot2_f32_bf16 v100, v80, s20, v100
    v_dot2_f32_bf16 v100, v81, s20, v100
    v_dot2_f32_bf16 v100, v82, s20, v100
    v_dot2_f32_bf16 v100, v83, s20, v100
    v_and_b32 v56, 0xffff0000, v26
    v_and_b32 v57, 0xffff0000, v30
    v_and_b32 v58, 0xffff0000, v34
    v_and_b32 v59, 0xffff0000, v38
    v_and_b32 v60, 0xffff0000, v42
    v_and_b32 v61, 0xffff0000, v46
    v_and_b32 v62, 0xffff0000, v50
    v_and_b32 v63, 0xffff0000, v54
    v_fmac_f32 v109, v56, v16
    v_fmac_f32 v109, v57, v17
    v_fmac_f32 v109, v58, v18
    v_fmac_f32 v109, v59, v19
    v_fmac_f32 v109, v60, v20
    v_fmac_f32 v109, v61, v21
    v_fmac_f32 v109, v62, v22
    v_fmac_f32 v109, v63, v23
    v_mul_f32 v56, v56, v8
    v_mul_f32 v57, v57, v9
    v_mul_f32 v58, v58, v10
    v_mul_f32 v59, v59, v11
    v_mul_f32 v60, v60, v12
    v_mul_f32 v61, v61, v13
    v_mul_f32 v62, v62, v14
    v_mul_f32 v63, v63, v15
    v_cvt_pk_bf16_f32 v84, v56, v57
    v_cvt_pk_bf16_f32 v85, v58, v59
    v_cvt_pk_bf16_f32 v86, v60, v61
    v_cvt_pk_bf16_f32 v87, v62, v63
    ds_write_b128 v6, v[84:87] offset:80
    v_dot2_f32_bf16 v101, v84, s20, v101
    v_dot2_f32_bf16 v101, v85, s20, v101
    v_dot2_f32_bf16 v101, v86, s20, v101
    v_dot2_f32_bf16 v101, v87, s20, v101
    v_lshlrev_b32 v56, 16, v27
    v_lshlrev_b32 v57, 16, v31
    v_lshlrev_b32 v58, 16, v35
    v_lshlrev_b32 v59, 16, v39
    v_lshlrev_b32 v60, 16, v43
    v_lshlrev_b32 v61, 16, v47
    v_lshlrev_b32 v62, 16, v51
    v_lshlrev_b32 v63, 16, v55
    v_fmac_f32 v110, v56, v16
    v_fmac_f32 v110, v57, v17
    v_fmac_f32 v110, v58, v18
    v_fmac_f32 v110, v59, v19
    v_fmac_f32 v110, v60, v20
    v_fmac_f32 v110, v61, v21
    v_fmac_f32 v110, v62, v22
    v_fmac_f32 v110, v63, v23
    v_mul_f32 v56, v56, v8
    v_mul_f32 v57, v57, v9
    v_mul_f32 v58, v58, v10
    v_mul_f32 v59, v59, v11
    v_mul_f32 v60, v60, v12
    v_mul_f32 v61, v61, v13
    v_mul_f32 v62, v62, v14
    v_mul_f32 v63, v63, v15
    v_cvt_pk_bf16_f32 v88, v56, v57
    v_cvt_pk_bf16_f32 v89, v58, v59
    v_cvt_pk_bf16_f32 v90, v60, v61
    v_cvt_pk_bf16_f32 v91, v62, v63
    ds_write_b128 v6, v[88:91] offset:96
    v_dot2_f32_bf16 v102, v88, s20, v102
    v_dot2_f32_bf16 v102, v89, s20, v102
    v_dot2_f32_bf16 v102, v90, s20, v102
    v_dot2_f32_bf16 v102, v91, s20, v102
    v_and_b32 v56, 0xffff0000, v27
    v_and_b32 v57, 0xffff0000, v31
    v_and_b32 v58, 0xffff0000, v35
    v_and_b32 v59, 0xffff0000, v39
    v_and_b32 v60, 0xffff0000, v43
    v_and_b32 v61, 0xffff0000, v47
    v_and_b32 v62, 0xffff0000, v51
    v_and_b32 v63, 0xffff0000, v55
    v_fmac_f32 v111, v56, v16
    v_fmac_f32 v111, v57, v17
    v_fmac_f32 v111, v58, v18
    v_fmac_f32 v111, v59, v19
    v_fmac_f32 v111, v60, v20
    v_fmac_f32 v111, v61, v21
    v_fmac_f32 v111, v62, v22
    v_fmac_f32 v111, v63, v23
    v_mul_f32 v56, v56, v8
    v_mul_f32 v57, v57, v9
    v_mul_f32 v58, v58, v10
    v_mul_f32 v59, v59, v11
    v_mul_f32 v60, v60, v12
    v_mul_f32 v61, v61, v13
    v_mul_f32 v62, v62, v14
    v_mul_f32 v63, v63, v15
    v_cvt_pk_bf16_f32 v92, v56, v57
    v_cvt_pk_bf16_f32 v93, v58, v59
    v_cvt_pk_bf16_f32 v94, v60, v61
    v_cvt_pk_bf16_f32 v95, v62, v63
    ds_write_b128 v6, v[92:95] offset:112
    v_dot2_f32_bf16 v103, v92, s20, v103
    v_dot2_f32_bf16 v103, v93, s20, v103
    v_dot2_f32_bf16 v103, v94, s20, v103
    v_dot2_f32_bf16 v103, v95, s20, v103
    v_lshrrev_b32 v56, 6, v0
    v_and_b32 v57, 63, v0
    v_mul_u32_u24 v58, 9216, v56
    v_lshrrev_b32 v59, 3, v57
    v_mul_u32_u24 v59, 144, v59
    v_add_u32 v58, v58, v59
    v_and_b32 v59, 7, v57
    v_lshl_add_u32 v58, v59, 4, v58
    s_waitcnt lgkmcnt(0)
    ds_read_b128 v[64:67], v58 offset:0
    ds_read_b128 v[68:71], v58 offset:1152
    ds_read_b128 v[72:75], v58 offset:2304
    ds_read_b128 v[76:79], v58 offset:3456
    ds_read_b128 v[80:83], v58 offset:4608
    ds_read_b128 v[84:87], v58 offset:5760
    ds_read_b128 v[88:91], v58 offset:6912
    ds_read_b128 v[92:95], v58 offset:8064
    v_lshlrev_b32 v59, 13, v56
    v_lshl_add_u32 v59, v57, 4, v59
    s_waitcnt lgkmcnt(7)
    buffer_store_dwordx4 v[64:67], v59, s[4:7], s17 offen
    s_add_u32 s17, s17, 1024
    s_waitcnt lgkmcnt(6)
    buffer_store_dwordx4 v[68:71], v59, s[4:7], s17 offen
    s_add_u32 s17, s17, 1024
    s_waitcnt lgkmcnt(5)
    buffer_store_dwordx4 v[72:75], v59, s[4:7], s17 offen
    s_add_u32 s17, s17, 1024
    s_waitcnt lgkmcnt(4)
    buffer_store_dwordx4 v[76:79], v59, s[4:7], s17 offen
    s_add_u32 s17, s17, 1024
    s_waitcnt lgkmcnt(3)
    buffer_store_dwordx4 v[80:83], v59, s[4:7], s17 offen
    s_add_u32 s17, s17, 1024
    s_waitcnt lgkmcnt(2)
    buffer_store_dwordx4 v[84:87], v59, s[4:7], s17 offen
    s_add_u32 s17, s17, 1024
    s_waitcnt lgkmcnt(1)
    buffer_store_dwordx4 v[88:91], v59, s[4:7], s17 offen
    s_add_u32 s17, s17, 1024
    s_waitcnt lgkmcnt(0)
    buffer_store_dwordx4 v[92:95], v59, s[4:7], s17 offen
    s_add_u32 s17, s17, 1024
    s_barrier
    v_lshlrev_b32 v4, 5, v0
    ds_write_b128 v4, v[96:99]
    ds_write_b128 v4, v[100:103] offset:16
    ds_write_b128 v4, v[104:107] offset:8192
    ds_write_b128 v4, v[108:111] offset:8208
    s_waitcnt lgkmcnt(0)
    s_barrier
    v_bfe_u32 v1, v0, 5, 1
    v_lshlrev_b32 v5, 1, v5
    v_lshl_add_u32 v5, v1, 13, v5
    ds_read_b32 v8, v5 offset:0
    ds_read_b32 v9, v5 offset:128
    ds_read_b32 v10, v5 offset:256
    ds_read_b32 v11, v5 offset:384
    ds_read_b32 v12, v5 offset:512
    ds_read_b32 v13, v5 offset:640
    ds_read_b32 v14, v5 offset:768
    ds_read_b32 v15, v5 offset:896
    ds_read_b32 v16, v5 offset:1024
    ds_read_b32 v17, v5 offset:1152
    ds_read_b32 v18, v5 offset:1280
    ds_read_b32 v19, v5 offset:1408
    ds_read_b32 v20, v5 offset:1536
    ds_read_b32 v21, v5 offset:1664
    ds_read_b32 v22, v5 offset:1792
    ds_read_b32 v23, v5 offset:1920
    ds_read_b32 v24, v5 offset:2048
    ds_read_b32 v25, v5 offset:2176
    ds_read_b32 v26, v5 offset:2304
    ds_read_b32 v27, v5 offset:2432
    ds_read_b32 v28, v5 offset:2560
    ds_read_b32 v29, v5 offset:2688
    ds_read_b32 v30, v5 offset:2816
    ds_read_b32 v31, v5 offset:2944
    ds_read_b32 v32, v5 offset:3072
    ds_read_b32 v33, v5 offset:3200
    ds_read_b32 v34, v5 offset:3328
    ds_read_b32 v35, v5 offset:3456
    ds_read_b32 v36, v5 offset:3584
    ds_read_b32 v37, v5 offset:3712
    ds_read_b32 v38, v5 offset:3840
    ds_read_b32 v39, v5 offset:3968
    ds_read_b32 v40, v5 offset:4096
    ds_read_b32 v41, v5 offset:4224
    ds_read_b32 v42, v5 offset:4352
    ds_read_b32 v43, v5 offset:4480
    ds_read_b32 v44, v5 offset:4608
    ds_read_b32 v45, v5 offset:4736
    ds_read_b32 v46, v5 offset:4864
    ds_read_b32 v47, v5 offset:4992
    ds_read_b32 v48, v5 offset:5120
    ds_read_b32 v49, v5 offset:5248
    ds_read_b32 v50, v5 offset:5376
    ds_read_b32 v51, v5 offset:5504
    ds_read_b32 v52, v5 offset:5632
    ds_read_b32 v53, v5 offset:5760
    ds_read_b32 v54, v5 offset:5888
    ds_read_b32 v55, v5 offset:6016
    ds_read_b32 v56, v5 offset:6144
    ds_read_b32 v57, v5 offset:6272
    ds_read_b32 v58, v5 offset:6400
    ds_read_b32 v59, v5 offset:6528
    ds_read_b32 v60, v5 offset:6656
    ds_read_b32 v61, v5 offset:6784
    ds_read_b32 v62, v5 offset:6912
    ds_read_b32 v63, v5 offset:7040
    ds_read_b32 v64, v5 offset:7168
    ds_read_b32 v65, v5 offset:7296
    ds_read_b32 v66, v5 offset:7424
    ds_read_b32 v67, v5 offset:7552
    ds_read_b32 v68, v5 offset:7680
    ds_read_b32 v69, v5 offset:7808
    ds_read_b32 v70, v5 offset:7936
    ds_read_b32 v71, v5 offset:8064
    s_waitcnt lgkmcnt(0) vmcnt(8)
    v_add_f32 v8, v8, v40
    v_add_f32 v9, v9, v41
    v_add_f32 v10, v10, v42
    v_add_f32 v11, v11, v43
    v_add_f32 v12, v12, v44
    v_add_f32 v13, v13, v45
    v_add_f32 v14, v14, v46
    v_add_f32 v15, v15, v47
    v_add_f32 v16, v16, v48
    v_add_f32 v17, v17, v49
    v_add_f32 v18, v18, v50
    v_add_f32 v19, v19, v51
    v_add_f32 v20, v20, v52
    v_add_f32 v21, v21, v53
    v_add_f32 v22, v22, v54
    v_add_f32 v23, v23, v55
    v_add_f32 v24, v24, v56
    v_add_f32 v25, v25, v57
    v_add_f32 v26, v26, v58
    v_add_f32 v27, v27, v59
    v_add_f32 v28, v28, v60
    v_add_f32 v29, v29, v61
    v_add_f32 v30, v30, v62
    v_add_f32 v31, v31, v63
    v_add_f32 v32, v32, v64
    v_add_f32 v33, v33, v65
    v_add_f32 v34, v34, v66
    v_add_f32 v35, v35, v67
    v_add_f32 v36, v36, v68
    v_add_f32 v37, v37, v69
    v_add_f32 v38, v38, v70
    v_add_f32 v39, v39, v71
    v_add_f32 v8, v8, v24
    v_add_f32 v9, v9, v25
    v_add_f32 v10, v10, v26
    v_add_f32 v11, v11, v27
    v_add_f32 v12, v12, v28
    v_add_f32 v13, v13, v29
    v_add_f32 v14, v14, v30
    v_add_f32 v15, v15, v31
    v_add_f32 v16, v16, v32
    v_add_f32 v17, v17, v33
    v_add_f32 v18, v18, v34
    v_add_f32 v19, v19, v35
    v_add_f32 v20, v20, v36
    v_add_f32 v21, v21, v37
    v_add_f32 v22, v22, v38
    v_add_f32 v23, v23, v39
    v_add_f32 v8, v8, v16
    v_add_f32 v9, v9, v17
    v_add_f32 v10, v10, v18
    v_add_f32 v11, v11, v19
    v_add_f32 v12, v12, v20
    v_add_f32 v13, v13, v21
    v_add_f32 v14, v14, v22
    v_add_f32 v15, v15, v23
    v_add_f32 v8, v8, v12
    v_add_f32 v9, v9, v13
    v_add_f32 v10, v10, v14
    v_add_f32 v11, v11, v15
    v_add_f32 v8, v8, v10
    v_add_f32 v9, v9, v11
    v_add_f32 v8, v8, v9
    v_lshlrev_b32 v7, 16, v7
    v_cvt_f32_u32 v1, v1
    v_fmac_f32 v8, v7, v1
    s_lshl_b32 s17, s16, 7
    s_add_u32 s17, s17, 0x4000
    buffer_store_dword v8, v5, s[4:7], s17 offen
    s_endpgm
C_CV:
    s_load_dwordx2 s[32:33], s[0:1], 8
    s_mov_b32 s34, 0x20000
    s_mov_b32 s35, 0x00020000
    s_load_dwordx2 s[36:37], s[0:1], 16
    s_mov_b32 s38, 0x20000
    s_mov_b32 s39, 0x00020000
    s_load_dwordx2 s[40:41], s[0:1], 24
    s_mov_b32 s42, 0x20000
    s_mov_b32 s43, 0x00020000
    s_load_dwordx2 s[44:45], s[0:1], 32
    s_mov_b32 s46, 0x20000
    s_mov_b32 s47, 0x00020000
    s_load_dwordx2 s[48:49], s[0:1], 40
    s_mov_b32 s50, 0x20000
    s_mov_b32 s51, 0x00020000
    s_load_dwordx2 s[52:53], s[0:1], 48
    s_mov_b32 s54, 0x20000
    s_mov_b32 s55, 0x00020000
    s_load_dwordx2 s[12:13], s[0:1], 56
    s_mov_b32 s14, 0x400
    s_mov_b32 s15, 0x00020000
    s_load_dwordx2 s[8:9], s[0:1], 64
    s_sub_u32 s16, s2, 232
    s_lshl_b32 s17, s16, 2
    s_and_b32 s18, s16, 0x1fe
    s_lshl_b32 s18, s18, 1
    v_lshlrev_b32 v1, 5, v0
    v_lshlrev_b32 v2, 4, v0
    s_lshl_b32 s19, s16, 13
    s_add_u32 s19, s19, 0x600000
    s_lshl_b32 s20, s16, 8
    s_lshl_b32 s21, s16, 1
    s_add_u32 s22, s17, 2048
    s_add_u32 s23, s17, 4096
    v_and_b32 v73, 127, v0
    v_lshlrev_b32 v74, 1, v73
    v_mov_b32 v4, 0
    s_waitcnt lgkmcnt(0)
    buffer_load_ushort v16, v74, s[32:35], s20 offen
    buffer_load_ushort v17, v74, s[36:39], s20 offen
    buffer_load_ushort v18, v74, s[40:43], s20 offen
    buffer_load_ushort v19, v74, s[44:47], s20 offen
    buffer_load_ushort v20, v74, s[48:51], s20 offen
    buffer_load_ushort v21, v74, s[52:55], s20 offen
    buffer_load_ushort v22, v4, s[12:15], s21 offen
    s_load_dword s27, s[8:9], s18
    v_mov_b32 v5, 0
    v_mov_b32 v6, 0
    v_mov_b32 v7, 0
    v_min_u32 v3, 29, v0
    v_lshlrev_b32 v3, 4, v3
    ds_write_b128 v3, v[4:7] offset:33280
    ds_write_b32 v4, v4 offset:37920
    v_and_b32 v3, 7, v0
    v_mul_u32_u24 v3, 4160, v3
    v_and_b32 v64, 63, v0
    v_lshrrev_b32 v65, 6, v0
    v_lshrrev_b32 v66, 4, v64
    v_bfe_u32 v67, v64, 3, 1
    v_sub_u32 v68, v66, v67
    v_lshlrev_b32 v68, 4, v68
    v_add_u32 v68, v68, v3
    v_lshlrev_b32 v69, 7, v65
    v_sub_u32 v68, v68, v69
    v_add_u32 v68, 400, v68
    v_and_b32 v70, 15, v64
    v_lshlrev_b32 v71, 5, v70
    v_lshl_add_u32 v71, v66, 4, v71
    v_sub_u32 v69, v71, v69
    v_add_u32 v69, 33664, v69
    v_lshlrev_b32 v71, 1, v71
    v_lshlrev_b32 v72, 4, v66
    v_sub_u32 v71, v71, v72
    v_lshl_add_u32 v71, v65, 13, v71
    v_readfirstlane_b32 s29, v65
    v_lshlrev_b32 v23, 3, v0
    v_sub_u32 v23, 2047, v23
    v_cvt_f32_i32 v23, v23
    v_subrev_f32 v124, 0.0, v23
    v_subrev_f32 v125, 1.0, v23
    v_subrev_f32 v126, 2.0, v23
    v_add_f32 v127, 0xc0400000, v23
    v_subrev_f32 v128, 4.0, v23
    v_add_f32 v129, 0xc0a00000, v23
    v_add_f32 v130, 0xc0c00000, v23
    v_add_f32 v131, 0xc0e00000, v23
    v_add_f32 v132, 0xc1000000, v23
    v_add_f32 v133, 0xc1100000, v23
    v_add_f32 v134, 0xc1200000, v23
    v_add_f32 v135, 0xc1300000, v23
    v_add_f32 v136, 0xc1400000, v23
    v_add_f32 v137, 0xc1500000, v23
    v_add_f32 v138, 0xc1600000, v23
    v_add_f32 v139, 0xc1700000, v23
    v_cvt_pk_bf16_f32 v24, v124, v125
    v_lshlrev_b32 v124, 16, v24
    v_and_b32 v125, 0xffff0000, v24
    v_cvt_pk_bf16_f32 v24, v126, v127
    v_lshlrev_b32 v126, 16, v24
    v_and_b32 v127, 0xffff0000, v24
    v_cvt_pk_bf16_f32 v24, v128, v129
    v_lshlrev_b32 v128, 16, v24
    v_and_b32 v129, 0xffff0000, v24
    v_cvt_pk_bf16_f32 v24, v130, v131
    v_lshlrev_b32 v130, 16, v24
    v_and_b32 v131, 0xffff0000, v24
    v_cvt_pk_bf16_f32 v24, v132, v133
    v_lshlrev_b32 v132, 16, v24
    v_and_b32 v133, 0xffff0000, v24
    v_cvt_pk_bf16_f32 v24, v134, v135
    v_lshlrev_b32 v134, 16, v24
    v_and_b32 v135, 0xffff0000, v24
    v_cvt_pk_bf16_f32 v24, v136, v137
    v_lshlrev_b32 v136, 16, v24
    v_and_b32 v137, 0xffff0000, v24
    v_cvt_pk_bf16_f32 v24, v138, v139
    v_lshlrev_b32 v138, 16, v24
    v_and_b32 v139, 0xffff0000, v24
    v_cvt_i32_f32 v124, v124
    v_cvt_i32_f32 v125, v125
    v_cvt_i32_f32 v126, v126
    v_cvt_i32_f32 v127, v127
    v_cvt_i32_f32 v128, v128
    v_cvt_i32_f32 v129, v129
    v_cvt_i32_f32 v130, v130
    v_cvt_i32_f32 v131, v131
    v_cvt_i32_f32 v132, v132
    v_cvt_i32_f32 v133, v133
    v_cvt_i32_f32 v134, v134
    v_cvt_i32_f32 v135, v135
    v_cvt_i32_f32 v136, v136
    v_cvt_i32_f32 v137, v137
    v_cvt_i32_f32 v138, v138
    v_mov_b32 v25, 32
    v_lshrrev_b32 v24, 3, v124
    v_add_lshl_u32 v124, v124, v24, 2
    v_lshrrev_b32 v24, 3, v125
    v_add_lshl_u32 v125, v125, v24, 2
    v_lshrrev_b32 v24, 3, v126
    v_add_lshl_u32 v126, v126, v24, 2
    v_lshrrev_b32 v24, 3, v127
    v_add_lshl_u32 v127, v127, v24, 2
    v_lshrrev_b32 v24, 3, v128
    v_add_lshl_u32 v128, v128, v24, 2
    v_lshrrev_b32 v24, 3, v129
    v_add_lshl_u32 v129, v129, v24, 2
    v_lshrrev_b32 v24, 3, v130
    v_add_lshl_u32 v130, v130, v24, 2
    v_lshrrev_b32 v24, 3, v131
    v_add_lshl_u32 v131, v131, v24, 2
    v_cmp_gt_i32 vcc, 0, v132
    v_lshrrev_b32 v24, 3, v132
    v_add_lshl_u32 v132, v132, v24, 2
    v_cndmask_b32 v132, v132, v25, vcc
    v_cmp_gt_i32 vcc, 0, v133
    v_lshrrev_b32 v24, 3, v133
    v_add_lshl_u32 v133, v133, v24, 2
    v_cndmask_b32 v133, v133, v25, vcc
    v_cmp_gt_i32 vcc, 0, v134
    v_lshrrev_b32 v24, 3, v134
    v_add_lshl_u32 v134, v134, v24, 2
    v_cndmask_b32 v134, v134, v25, vcc
    v_cmp_gt_i32 vcc, 0, v135
    v_lshrrev_b32 v24, 3, v135
    v_add_lshl_u32 v135, v135, v24, 2
    v_cndmask_b32 v135, v135, v25, vcc
    v_cmp_gt_i32 vcc, 0, v136
    v_lshrrev_b32 v24, 3, v136
    v_add_lshl_u32 v136, v136, v24, 2
    v_cndmask_b32 v136, v136, v25, vcc
    v_cmp_gt_i32 vcc, 0, v137
    v_lshrrev_b32 v24, 3, v137
    v_add_lshl_u32 v137, v137, v24, 2
    v_cndmask_b32 v137, v137, v25, vcc
    v_cmp_gt_i32 vcc, 0, v138
    v_lshrrev_b32 v24, 3, v138
    v_add_lshl_u32 v138, v138, v24, 2
    v_cndmask_b32 v138, v138, v25, vcc
    s_waitcnt vmcnt(0)
    v_lshlrev_b32 v16, 16, v16
    v_lshlrev_b32 v17, 16, v17
    v_lshlrev_b32 v18, 16, v18
    v_lshlrev_b32 v19, 16, v19
    v_lshlrev_b32 v20, 16, v20
    v_lshlrev_b32 v21, 16, v21
    v_lshlrev_b32 v22, 16, v22
    v_mul_f32 v22, 0x3fb8aa3b, v22
    v_exp_f32 v22, v22
    s_nop 0
    v_cvt_pk_bf16_f32 v22, v22, v22
    v_and_b32 v22, 0xffff0000, v22
    v_mul_f32 v24, v22, v16
    v_mul_f32 v24, 0x3fb8aa3b, v24
    v_mul_f32 v25, v22, v17
    v_mul_f32 v25, 0.15915494, v25
    v_mul_f32 v18, v22, v18
    v_mul_f32 v19, v22, v19
    v_mul_f32 v26, v20, v18
    v_fma_f32 v26, -v21, v19, v26
    v_mul_f32 v27, v20, v19
    v_fmac_f32 v27, v21, v18
    v_lshlrev_b32 v73, 2, v73
    v_mul_f32 v20, 0x43000000, v24
    v_mul_f32 v21, 0x43000000, v25
    v_exp_f32 v20, v20
    v_fract_f32 v21, v21
    s_nop 0
    v_cos_f32 v32, v21
    v_sin_f32 v33, v21
    s_nop 0
    v_mul_f32 v32, v32, v20
    v_mul_f32 v33, v33, v20
    s_cmp_lt_u32 s29, 2
    s_cbranch_scc1 C_H0
    v_mul_f32 v20, 4.0, v24
    v_mul_f32 v21, 4.0, v25
    v_exp_f32 v20, v20
    v_fract_f32 v21, v21
    s_nop 0
    v_cos_f32 v34, v21
    v_sin_f32 v35, v21
    s_nop 0
    v_mul_f32 v34, v34, v20
    v_mul_f32 v35, v35, v20
    v_mov_b32 v36, 0x3f80
    ds_write_b32 v73, v36
    v_cvt_pk_bf16_f32 v104, v32, v33
    ds_write_b32 v73, v104 offset:528
    v_cvt_pk_bf16_f32 v105, v34, v35
    ds_write_b32 v73, v105 offset:8448
    v_pk_mul_f32 v[22:23], v[32:33], v[34:35] op_sel:[0,0] op_sel_hi:[1,0]
    v_pk_fma_f32 v[40:41], v[32:33], v[34:35], v[22:23] op_sel:[1,1,0] op_sel_hi:[0,1,1] neg_lo:[1,0,0]
    v_cvt_pk_bf16_f32 v106, v40, v41
    ds_write_b32 v73, v106 offset:10560
    v_pk_mul_f32 v[22:23], v[32:33], v[32:33] op_sel:[0,0] op_sel_hi:[1,0]
    v_pk_fma_f32 v[36:37], v[32:33], v[32:33], v[22:23] op_sel:[1,1,0] op_sel_hi:[0,1,1] neg_lo:[1,0,0]
    v_cvt_pk_bf16_f32 v107, v36, v37
    ds_write_b32 v73, v107 offset:1056
    v_pk_mul_f32 v[22:23], v[36:37], v[34:35] op_sel:[0,0] op_sel_hi:[1,0]
    v_pk_fma_f32 v[40:41], v[36:37], v[34:35], v[22:23] op_sel:[1,1,0] op_sel_hi:[0,1,1] neg_lo:[1,0,0]
    v_cvt_pk_bf16_f32 v108, v40, v41
    ds_write_b32 v73, v108 offset:12672
    v_pk_mul_f32 v[22:23], v[36:37], v[32:33] op_sel:[0,0] op_sel_hi:[1,0]
    v_pk_fma_f32 v[38:39], v[36:37], v[32:33], v[22:23] op_sel:[1,1,0] op_sel_hi:[0,1,1] neg_lo:[1,0,0]
    v_cvt_pk_bf16_f32 v109, v38, v39
    ds_write_b32 v73, v109 offset:1584
    v_pk_mul_f32 v[22:23], v[38:39], v[34:35] op_sel:[0,0] op_sel_hi:[1,0]
    v_pk_fma_f32 v[40:41], v[38:39], v[34:35], v[22:23] op_sel:[1,1,0] op_sel_hi:[0,1,1] neg_lo:[1,0,0]
    v_cvt_pk_bf16_f32 v110, v40, v41
    ds_write_b32 v73, v110 offset:14784
    v_pk_mul_f32 v[22:23], v[38:39], v[32:33] op_sel:[0,0] op_sel_hi:[1,0]
    v_pk_fma_f32 v[36:37], v[38:39], v[32:33], v[22:23] op_sel:[1,1,0] op_sel_hi:[0,1,1] neg_lo:[1,0,0]
    v_cvt_pk_bf16_f32 v111, v36, v37
    ds_write_b32 v73, v111 offset:2112
    v_pk_mul_f32 v[22:23], v[36:37], v[34:35] op_sel:[0,0] op_sel_hi:[1,0]
    v_pk_fma_f32 v[40:41], v[36:37], v[34:35], v[22:23] op_sel:[1,1,0] op_sel_hi:[0,1,1] neg_lo:[1,0,0]
    v_cvt_pk_bf16_f32 v104, v40, v41
    ds_write_b32 v73, v104 offset:8976
    v_pk_mul_f32 v[22:23], v[36:37], v[32:33] op_sel:[0,0] op_sel_hi:[1,0]
    v_pk_fma_f32 v[38:39], v[36:37], v[32:33], v[22:23] op_sel:[1,1,0] op_sel_hi:[0,1,1] neg_lo:[1,0,0]
    v_cvt_pk_bf16_f32 v105, v38, v39
    ds_write_b32 v73, v105 offset:2640
    v_pk_mul_f32 v[22:23], v[38:39], v[34:35] op_sel:[0,0] op_sel_hi:[1,0]
    v_pk_fma_f32 v[40:41], v[38:39], v[34:35], v[22:23] op_sel:[1,1,0] op_sel_hi:[0,1,1] neg_lo:[1,0,0]
    v_cvt_pk_bf16_f32 v106, v40, v41
    ds_write_b32 v73, v106 offset:11088
    v_pk_mul_f32 v[22:23], v[38:39], v[32:33] op_sel:[0,0] op_sel_hi:[1,0]
    v_pk_fma_f32 v[36:37], v[38:39], v[32:33], v[22:23] op_sel:[1,1,0] op_sel_hi:[0,1,1] neg_lo:[1,0,0]
    v_cvt_pk_bf16_f32 v107, v36, v37
    ds_write_b32 v73, v107 offset:3168
    v_pk_mul_f32 v[22:23], v[36:37], v[34:35] op_sel:[0,0] op_sel_hi:[1,0]
    v_pk_fma_f32 v[40:41], v[36:37], v[34:35], v[22:23] op_sel:[1,1,0] op_sel_hi:[0,1,1] neg_lo:[1,0,0]
    v_cvt_pk_bf16_f32 v108, v40, v41
    ds_write_b32 v73, v108 offset:13200
    v_pk_mul_f32 v[22:23], v[36:37], v[32:33] op_sel:[0,0] op_sel_hi:[1,0]
    v_pk_fma_f32 v[38:39], v[36:37], v[32:33], v[22:23] op_sel:[1,1,0] op_sel_hi:[0,1,1] neg_lo:[1,0,0]
    v_cvt_pk_bf16_f32 v109, v38, v39
    ds_write_b32 v73, v109 offset:3696
    v_pk_mul_f32 v[22:23], v[38:39], v[34:35] op_sel:[0,0] op_sel_hi:[1,0]
    v_pk_fma_f32 v[40:41], v[38:39], v[34:35], v[22:23] op_sel:[1,1,0] op_sel_hi:[0,1,1] neg_lo:[1,0,0]
    v_cvt_pk_bf16_f32 v110, v40, v41
    ds_write_b32 v73, v110 offset:15312
    v_pk_mul_f32 v[22:23], v[38:39], v[32:33] op_sel:[0,0] op_sel_hi:[1,0]
    v_pk_fma_f32 v[36:37], v[38:39], v[32:33], v[22:23] op_sel:[1,1,0] op_sel_hi:[0,1,1] neg_lo:[1,0,0]
    v_cvt_pk_bf16_f32 v111, v36, v37
    ds_write_b32 v73, v111 offset:4224
    v_pk_mul_f32 v[22:23], v[36:37], v[32:33] op_sel:[0,0] op_sel_hi:[1,0]
    v_pk_fma_f32 v[38:39], v[36:37], v[32:33], v[22:23] op_sel:[1,1,0] op_sel_hi:[0,1,1] neg_lo:[1,0,0]
    v_cvt_pk_bf16_f32 v104, v38, v39
    ds_write_b32 v73, v104 offset:4752
    v_pk_mul_f32 v[22:23], v[38:39], v[32:33] op_sel:[0,0] op_sel_hi:[1,0]
    v_pk_fma_f32 v[36:37], v[38:39], v[32:33], v[22:23] op_sel:[1,1,0] op_sel_hi:[0,1,1] neg_lo:[1,0,0]
    v_cvt_pk_bf16_f32 v105, v36, v37
    ds_write_b32 v73, v105 offset:5280
    v_pk_mul_f32 v[22:23], v[36:37], v[32:33] op_sel:[0,0] op_sel_hi:[1,0]
    v_pk_fma_f32 v[38:39], v[36:37], v[32:33], v[22:23] op_sel:[1,1,0] op_sel_hi:[0,1,1] neg_lo:[1,0,0]
    v_cvt_pk_bf16_f32 v106, v38, v39
    ds_write_b32 v73, v106 offset:5808
    v_pk_mul_f32 v[22:23], v[38:39], v[32:33] op_sel:[0,0] op_sel_hi:[1,0]
    v_pk_fma_f32 v[36:37], v[38:39], v[32:33], v[22:23] op_sel:[1,1,0] op_sel_hi:[0,1,1] neg_lo:[1,0,0]
    v_cvt_pk_bf16_f32 v107, v36, v37
    ds_write_b32 v73, v107 offset:6336
    v_pk_mul_f32 v[22:23], v[36:37], v[32:33] op_sel:[0,0] op_sel_hi:[1,0]
    v_pk_fma_f32 v[38:39], v[36:37], v[32:33], v[22:23] op_sel:[1,1,0] op_sel_hi:[0,1,1] neg_lo:[1,0,0]
    v_cvt_pk_bf16_f32 v108, v38, v39
    ds_write_b32 v73, v108 offset:6864
    v_pk_mul_f32 v[22:23], v[38:39], v[32:33] op_sel:[0,0] op_sel_hi:[1,0]
    v_pk_fma_f32 v[36:37], v[38:39], v[32:33], v[22:23] op_sel:[1,1,0] op_sel_hi:[0,1,1] neg_lo:[1,0,0]
    v_cvt_pk_bf16_f32 v109, v36, v37
    ds_write_b32 v73, v109 offset:7392
    v_pk_mul_f32 v[22:23], v[36:37], v[32:33] op_sel:[0,0] op_sel_hi:[1,0]
    v_pk_fma_f32 v[38:39], v[36:37], v[32:33], v[22:23] op_sel:[1,1,0] op_sel_hi:[0,1,1] neg_lo:[1,0,0]
    v_cvt_pk_bf16_f32 v110, v38, v39
    ds_write_b32 v73, v110 offset:7920
    v_pk_mul_f32 v[22:23], v[38:39], v[32:33] op_sel:[0,0] op_sel_hi:[1,0]
    v_pk_fma_f32 v[36:37], v[38:39], v[32:33], v[22:23] op_sel:[1,1,0] op_sel_hi:[0,1,1] neg_lo:[1,0,0]
    v_cvt_pk_bf16_f32 v111, v36, v37
    ds_write_b32 v73, v111 offset:21120
    s_branch C_HJ
C_H0:
    v_mul_f32 v20, 0x41000000, v24
    v_mul_f32 v21, 0x41000000, v25
    v_exp_f32 v20, v20
    v_fract_f32 v21, v21
    s_nop 0
    v_cos_f32 v34, v21
    v_sin_f32 v35, v21
    s_nop 0
    v_mul_f32 v34, v34, v20
    v_mul_f32 v35, v35, v20
    v_mul_f32 v20, 1.0, v24
    v_mul_f32 v21, 1.0, v25
    v_exp_f32 v20, v20
    v_fract_f32 v21, v21
    s_nop 0
    v_cos_f32 v42, v21
    v_sin_f32 v43, v21
    s_nop 0
    v_mul_f32 v42, v42, v20
    v_mul_f32 v43, v43, v20
    v_cvt_pk_bf16_f32 v104, v26, -v27
    ds_write_b32 v73, v104 offset:21648
    v_pk_mul_f32 v[22:23], v[26:27], v[34:35] op_sel:[0,0] op_sel_hi:[1,0]
    v_pk_fma_f32 v[38:39], v[26:27], v[34:35], v[22:23] op_sel:[1,1,0] op_sel_hi:[0,1,1] neg_lo:[1,0,0]
    v_cvt_pk_bf16_f32 v105, v38, -v39
    ds_write_b32 v73, v105 offset:22176
    v_pk_mul_f32 v[22:23], v[42:43], v[42:43] op_sel:[0,0] op_sel_hi:[1,0]
    v_pk_fma_f32 v[44:45], v[42:43], v[42:43], v[22:23] op_sel:[1,1,0] op_sel_hi:[0,1,1] neg_lo:[1,0,0]
    v_pk_mul_f32 v[22:23], v[38:39], v[34:35] op_sel:[0,0] op_sel_hi:[1,0]
    v_pk_fma_f32 v[36:37], v[38:39], v[34:35], v[22:23] op_sel:[1,1,0] op_sel_hi:[0,1,1] neg_lo:[1,0,0]
    v_cvt_pk_bf16_f32 v106, v36, -v37
    ds_write_b32 v73, v106 offset:22704
    v_pk_mul_f32 v[22:23], v[44:45], v[42:43] op_sel:[0,0] op_sel_hi:[1,0]
    v_pk_fma_f32 v[46:47], v[44:45], v[42:43], v[22:23] op_sel:[1,1,0] op_sel_hi:[0,1,1] neg_lo:[1,0,0]
    v_pk_mul_f32 v[22:23], v[44:45], v[44:45] op_sel:[0,0] op_sel_hi:[1,0]
    v_pk_fma_f32 v[48:49], v[44:45], v[44:45], v[22:23] op_sel:[1,1,0] op_sel_hi:[0,1,1] neg_lo:[1,0,0]
    v_pk_mul_f32 v[22:23], v[36:37], v[34:35] op_sel:[0,0] op_sel_hi:[1,0]
    v_pk_fma_f32 v[38:39], v[36:37], v[34:35], v[22:23] op_sel:[1,1,0] op_sel_hi:[0,1,1] neg_lo:[1,0,0]
    v_cvt_pk_bf16_f32 v107, v38, -v39
    ds_write_b32 v73, v107 offset:23232
    v_pk_mul_f32 v[22:23], v[48:49], v[42:43] op_sel:[0,0] op_sel_hi:[1,0]
    v_pk_fma_f32 v[50:51], v[48:49], v[42:43], v[22:23] op_sel:[1,1,0] op_sel_hi:[0,1,1] neg_lo:[1,0,0]
    v_pk_mul_f32 v[22:23], v[48:49], v[44:45] op_sel:[0,0] op_sel_hi:[1,0]
    v_pk_fma_f32 v[52:53], v[48:49], v[44:45], v[22:23] op_sel:[1,1,0] op_sel_hi:[0,1,1] neg_lo:[1,0,0]
    v_pk_mul_f32 v[22:23], v[48:49], v[46:47] op_sel:[0,0] op_sel_hi:[1,0]
    v_pk_fma_f32 v[54:55], v[48:49], v[46:47], v[22:23] op_sel:[1,1,0] op_sel_hi:[0,1,1] neg_lo:[1,0,0]
    v_pk_mul_f32 v[22:23], v[38:39], v[34:35] op_sel:[0,0] op_sel_hi:[1,0]
    v_pk_fma_f32 v[36:37], v[38:39], v[34:35], v[22:23] op_sel:[1,1,0] op_sel_hi:[0,1,1] neg_lo:[1,0,0]
    v_cvt_pk_bf16_f32 v108, v36, -v37
    ds_write_b32 v73, v108 offset:23760
    v_pk_mul_f32 v[22:23], v[32:33], v[32:33] op_sel:[0,0] op_sel_hi:[1,0]
    v_pk_fma_f32 v[56:57], v[32:33], v[32:33], v[22:23] op_sel:[1,1,0] op_sel_hi:[0,1,1] neg_lo:[1,0,0]
    v_pk_mul_f32 v[22:23], v[36:37], v[34:35] op_sel:[0,0] op_sel_hi:[1,0]
    v_pk_fma_f32 v[38:39], v[36:37], v[34:35], v[22:23] op_sel:[1,1,0] op_sel_hi:[0,1,1] neg_lo:[1,0,0]
    v_cvt_pk_bf16_f32 v109, v38, -v39
    ds_write_b32 v73, v109 offset:24288
    v_pk_mul_f32 v[22:23], v[56:57], v[32:33] op_sel:[0,0] op_sel_hi:[1,0]
    v_pk_fma_f32 v[58:59], v[56:57], v[32:33], v[22:23] op_sel:[1,1,0] op_sel_hi:[0,1,1] neg_lo:[1,0,0]
    v_pk_mul_f32 v[22:23], v[38:39], v[34:35] op_sel:[0,0] op_sel_hi:[1,0]
    v_pk_fma_f32 v[36:37], v[38:39], v[34:35], v[22:23] op_sel:[1,1,0] op_sel_hi:[0,1,1] neg_lo:[1,0,0]
    v_cvt_pk_bf16_f32 v110, v36, -v37
    ds_write_b32 v73, v110 offset:24816
    v_pk_mul_f32 v[22:23], v[36:37], v[34:35] op_sel:[0,0] op_sel_hi:[1,0]
    v_pk_fma_f32 v[38:39], v[36:37], v[34:35], v[22:23] op_sel:[1,1,0] op_sel_hi:[0,1,1] neg_lo:[1,0,0]
    v_cvt_pk_bf16_f32 v111, v38, -v39
    ds_write_b32 v73, v111 offset:25344
    v_pk_mul_f32 v[22:23], v[38:39], v[34:35] op_sel:[0,0] op_sel_hi:[1,0]
    v_pk_fma_f32 v[36:37], v[38:39], v[34:35], v[22:23] op_sel:[1,1,0] op_sel_hi:[0,1,1] neg_lo:[1,0,0]
    v_cvt_pk_bf16_f32 v104, v36, -v37
    ds_write_b32 v73, v104 offset:25872
    v_pk_mul_f32 v[22:23], v[36:37], v[34:35] op_sel:[0,0] op_sel_hi:[1,0]
    v_pk_fma_f32 v[38:39], v[36:37], v[34:35], v[22:23] op_sel:[1,1,0] op_sel_hi:[0,1,1] neg_lo:[1,0,0]
    v_cvt_pk_bf16_f32 v105, v38, -v39
    ds_write_b32 v73, v105 offset:26400
    v_pk_mul_f32 v[22:23], v[38:39], v[34:35] op_sel:[0,0] op_sel_hi:[1,0]
    v_pk_fma_f32 v[36:37], v[38:39], v[34:35], v[22:23] op_sel:[1,1,0] op_sel_hi:[0,1,1] neg_lo:[1,0,0]
    v_cvt_pk_bf16_f32 v106, v36, -v37
    ds_write_b32 v73, v106 offset:26928
    v_pk_mul_f32 v[22:23], v[36:37], v[34:35] op_sel:[0,0] op_sel_hi:[1,0]
    v_pk_fma_f32 v[38:39], v[36:37], v[34:35], v[22:23] op_sel:[1,1,0] op_sel_hi:[0,1,1] neg_lo:[1,0,0]
    v_cvt_pk_bf16_f32 v107, v38, -v39
    ds_write_b32 v73, v107 offset:27456
    v_pk_mul_f32 v[22:23], v[38:39], v[34:35] op_sel:[0,0] op_sel_hi:[1,0]
    v_pk_fma_f32 v[36:37], v[38:39], v[34:35], v[22:23] op_sel:[1,1,0] op_sel_hi:[0,1,1] neg_lo:[1,0,0]
    v_cvt_pk_bf16_f32 v108, v36, -v37
    ds_write_b32 v73, v108 offset:27984
    v_pk_mul_f32 v[22:23], v[36:37], v[34:35] op_sel:[0,0] op_sel_hi:[1,0]
    v_pk_fma_f32 v[38:39], v[36:37], v[34:35], v[22:23] op_sel:[1,1,0] op_sel_hi:[0,1,1] neg_lo:[1,0,0]
    v_cvt_pk_bf16_f32 v109, v38, -v39
    ds_write_b32 v73, v109 offset:28512
    v_pk_mul_f32 v[22:23], v[38:39], v[34:35] op_sel:[0,0] op_sel_hi:[1,0]
    v_pk_fma_f32 v[36:37], v[38:39], v[34:35], v[22:23] op_sel:[1,1,0] op_sel_hi:[0,1,1] neg_lo:[1,0,0]
    v_cvt_pk_bf16_f32 v110, v36, -v37
    ds_write_b32 v73, v110 offset:29040
    v_pk_mul_f32 v[22:23], v[36:37], v[34:35] op_sel:[0,0] op_sel_hi:[1,0]
    v_pk_fma_f32 v[38:39], v[36:37], v[34:35], v[22:23] op_sel:[1,1,0] op_sel_hi:[0,1,1] neg_lo:[1,0,0]
    v_cvt_pk_bf16_f32 v111, v38, -v39
    ds_write_b32 v73, v111 offset:29568
    v_cvt_pk_bf16_f32 v104, v42, v43
    ds_write_b32 v73, v104 offset:16896
    v_pk_mul_f32 v[22:23], v[42:43], v[32:33] op_sel:[0,0] op_sel_hi:[1,0]
    v_pk_fma_f32 v[60:61], v[42:43], v[32:33], v[22:23] op_sel:[1,1,0] op_sel_hi:[0,1,1] neg_lo:[1,0,0]
    v_cvt_pk_bf16_f32 v105, v60, v61
    ds_write_b32 v73, v105 offset:19008
    v_cvt_pk_bf16_f32 v106, v46, v47
    ds_write_b32 v73, v106 offset:17424
    v_pk_mul_f32 v[22:23], v[46:47], v[32:33] op_sel:[0,0] op_sel_hi:[1,0]
    v_pk_fma_f32 v[60:61], v[46:47], v[32:33], v[22:23] op_sel:[1,1,0] op_sel_hi:[0,1,1] neg_lo:[1,0,0]
    v_cvt_pk_bf16_f32 v107, v60, v61
    ds_write_b32 v73, v107 offset:19536
    v_cvt_pk_bf16_f32 v108, v50, v51
    ds_write_b32 v73, v108 offset:17952
    v_pk_mul_f32 v[22:23], v[50:51], v[32:33] op_sel:[0,0] op_sel_hi:[1,0]
    v_pk_fma_f32 v[60:61], v[50:51], v[32:33], v[22:23] op_sel:[1,1,0] op_sel_hi:[0,1,1] neg_lo:[1,0,0]
    v_cvt_pk_bf16_f32 v109, v60, v61
    ds_write_b32 v73, v109 offset:20064
    v_cvt_pk_bf16_f32 v110, v54, v55
    ds_write_b32 v73, v110 offset:18480
    v_pk_mul_f32 v[22:23], v[54:55], v[32:33] op_sel:[0,0] op_sel_hi:[1,0]
    v_pk_fma_f32 v[60:61], v[54:55], v[32:33], v[22:23] op_sel:[1,1,0] op_sel_hi:[0,1,1] neg_lo:[1,0,0]
    v_cvt_pk_bf16_f32 v111, v60, v61
    ds_write_b32 v73, v111 offset:20592
    v_cvt_pk_bf16_f32 v104, v44, v45
    ds_write_b32 v73, v104 offset:9504
    v_pk_mul_f32 v[22:23], v[44:45], v[32:33] op_sel:[0,0] op_sel_hi:[1,0]
    v_pk_fma_f32 v[60:61], v[44:45], v[32:33], v[22:23] op_sel:[1,1,0] op_sel_hi:[0,1,1] neg_lo:[1,0,0]
    v_cvt_pk_bf16_f32 v105, v60, v61
    ds_write_b32 v73, v105 offset:11616
    v_pk_mul_f32 v[22:23], v[44:45], v[56:57] op_sel:[0,0] op_sel_hi:[1,0]
    v_pk_fma_f32 v[60:61], v[44:45], v[56:57], v[22:23] op_sel:[1,1,0] op_sel_hi:[0,1,1] neg_lo:[1,0,0]
    v_cvt_pk_bf16_f32 v106, v60, v61
    ds_write_b32 v73, v106 offset:13728
    v_pk_mul_f32 v[22:23], v[44:45], v[58:59] op_sel:[0,0] op_sel_hi:[1,0]
    v_pk_fma_f32 v[60:61], v[44:45], v[58:59], v[22:23] op_sel:[1,1,0] op_sel_hi:[0,1,1] neg_lo:[1,0,0]
    v_cvt_pk_bf16_f32 v107, v60, v61
    ds_write_b32 v73, v107 offset:15840
    v_cvt_pk_bf16_f32 v108, v52, v53
    ds_write_b32 v73, v108 offset:10032
    v_pk_mul_f32 v[22:23], v[52:53], v[32:33] op_sel:[0,0] op_sel_hi:[1,0]
    v_pk_fma_f32 v[60:61], v[52:53], v[32:33], v[22:23] op_sel:[1,1,0] op_sel_hi:[0,1,1] neg_lo:[1,0,0]
    v_cvt_pk_bf16_f32 v109, v60, v61
    ds_write_b32 v73, v109 offset:12144
    v_pk_mul_f32 v[22:23], v[52:53], v[56:57] op_sel:[0,0] op_sel_hi:[1,0]
    v_pk_fma_f32 v[60:61], v[52:53], v[56:57], v[22:23] op_sel:[1,1,0] op_sel_hi:[0,1,1] neg_lo:[1,0,0]
    v_cvt_pk_bf16_f32 v110, v60, v61
    ds_write_b32 v73, v110 offset:14256
    v_pk_mul_f32 v[22:23], v[52:53], v[58:59] op_sel:[0,0] op_sel_hi:[1,0]
    v_pk_fma_f32 v[60:61], v[52:53], v[58:59], v[22:23] op_sel:[1,1,0] op_sel_hi:[0,1,1] neg_lo:[1,0,0]
    v_cvt_pk_bf16_f32 v111, v60, v61
    ds_write_b32 v73, v111 offset:16368
C_HJ:
    s_waitcnt lgkmcnt(0)
    s_and_b32 s28, s16, 1
    s_lshl_b32 s28, s28, 4
    s_lshr_b32 s27, s27, s28
    s_lshl_b32 s27, s27, 16
    s_barrier
    v_mul_u32_u24 v73, 528, v70
    v_lshl_add_u32 v73, v66, 4, v73
    s_mul_i32 s30, s29, 8448
    v_add_u32 v74, s30, v73
    s_cmp_eq_u32 s29, 3
    s_cbranch_scc1 C_T3
C_SK:
    ds_read_b128 v[32:35], v74 offset:0
    ds_read_b128 v[36:39], v73 offset:21648
    ds_read_b128 v[40:43], v74 offset:64
    ds_read_b128 v[44:47], v73 offset:21712
    ds_read_b128 v[48:51], v74 offset:128
    ds_read_b128 v[52:55], v73 offset:21776
    ds_read_b128 v[56:59], v74 offset:192
    ds_read_b128 v[60:63], v73 offset:21840
    ds_read_b128 v[76:79], v74 offset:256
    ds_read_b128 v[80:83], v73 offset:21904
    ds_read_b128 v[84:87], v74 offset:320
    ds_read_b128 v[88:91], v73 offset:21968
    ds_read_b128 v[92:95], v74 offset:384
    ds_read_b128 v[96:99], v73 offset:22032
    ds_read_b128 v[100:103], v74 offset:448
    ds_read_b128 v[104:107], v73 offset:22096
    v_mul_u32_u24 v28, 36, v70
    v_mul_u32_u24 v30, 576, v66
    v_add_u32 v30, v30, v28
    v_lshlrev_b32 v31, 2, v66
    v_add_u32 v31, 9204, v31
    v_add_u32 v31, v31, v28
    v_cmp_lt_u32 vcc, 1, v66
    v_mul_u32_u24 v29, 2304, v66
    v_add_u32 v29, v29, v28
    v_cndmask_b32 v31, v30, v31, vcc
    s_waitcnt lgkmcnt(0)
    v_mfma_f32_16x16x32_bf16 v[16:19], v[32:35], v[36:39], 0
    v_mfma_f32_16x16x32_bf16 v[16:19], v[40:43], v[44:47], v[16:19]
    v_mfma_f32_16x16x32_bf16 v[16:19], v[48:51], v[52:55], v[16:19]
    v_mfma_f32_16x16x32_bf16 v[16:19], v[56:59], v[60:63], v[16:19]
    v_mfma_f32_16x16x32_bf16 v[16:19], v[76:79], v[80:83], v[16:19]
    v_mfma_f32_16x16x32_bf16 v[16:19], v[84:87], v[88:91], v[16:19]
    v_mfma_f32_16x16x32_bf16 v[16:19], v[92:95], v[96:99], v[16:19]
    v_mfma_f32_16x16x32_bf16 v[16:19], v[100:103], v[104:107], v[16:19]
    s_nop 7
    s_cmp_eq_u32 s29, 1
    s_cbranch_scc1 C_T1
    s_cmp_eq_u32 s29, 2
    s_cbranch_scc1 C_T2
    ds_write_b32 v29, v16 offset:37888
    ds_write_b32 v29, v17 offset:38464
    ds_write_b32 v29, v18 offset:39040
    ds_write_b32 v29, v19 offset:39616
    s_branch C_T3
C_T1:
    ds_write_b32 v30, v16 offset:37904
    ds_write_b32 v30, v17 offset:40208
    ds_write_b32 v30, v18 offset:37896
    ds_write_b32 v30, v19 offset:37912
    s_branch C_T3
C_T2:
    ds_write_b32 v31, v16 offset:37892
    ds_write_b32 v31, v17 offset:37900
    ds_write_b32 v31, v18 offset:37908
    ds_write_b32 v31, v19 offset:37916
C_T3:
    s_waitcnt lgkmcnt(0)
    s_barrier
    ds_read_b32 v32, v124 offset:37888
    ds_read_b32 v33, v125 offset:37888
    ds_read_b32 v34, v126 offset:37888
    ds_read_b32 v35, v127 offset:37888
    ds_read_b32 v36, v128 offset:37888
    ds_read_b32 v37, v129 offset:37888
    ds_read_b32 v38, v130 offset:37888
    ds_read_b32 v39, v131 offset:37888
    ds_read_b32 v40, v132 offset:37888
    ds_read_b32 v41, v133 offset:37888
    ds_read_b32 v42, v134 offset:37888
    ds_read_b32 v43, v135 offset:37888
    ds_read_b32 v44, v136 offset:37888
    ds_read_b32 v45, v137 offset:37888
    ds_read_b32 v46, v138 offset:37888
    ds_write_b128 v3, v[4:7] offset:4096
    s_waitcnt lgkmcnt(1)
    v_cvt_pk_bf16_f32 v76, v32, v33
    v_cvt_pk_bf16_f32 v77, v34, v35
    v_cvt_pk_bf16_f32 v78, v36, v37
    v_cvt_pk_bf16_f32 v79, v38, v39
    v_cvt_pk_bf16_f32 v80, v40, v41
    v_cvt_pk_bf16_f32 v81, v42, v43
    v_cvt_pk_bf16_f32 v84, v34, v35
    v_cvt_pk_bf16_f32 v85, v36, v37
    v_cvt_pk_bf16_f32 v86, v38, v39
    v_cvt_pk_bf16_f32 v87, v40, v41
    v_cvt_pk_bf16_f32 v88, v42, v43
    v_cvt_pk_bf16_f32 v89, v44, v45
    v_cvt_pk_bf16_f32 v92, v33, v34
    v_cvt_pk_bf16_f32 v93, v35, v36
    v_cvt_pk_bf16_f32 v94, v37, v38
    v_cvt_pk_bf16_f32 v95, v39, v40
    v_cvt_pk_bf16_f32 v96, v41, v42
    v_cvt_pk_bf16_f32 v97, v43, v44
    v_cvt_pk_bf16_f32 v100, v35, v36
    v_cvt_pk_bf16_f32 v101, v37, v38
    v_cvt_pk_bf16_f32 v102, v39, v40
    v_cvt_pk_bf16_f32 v103, v41, v42
    v_cvt_pk_bf16_f32 v104, v43, v44
    v_cvt_pk_bf16_f32 v105, v45, v46
    ds_write_b128 v2, v[102:105] offset:0
    ds_write_b128 v2, v[86:89] offset:4160
    ds_write_b128 v2, v[94:97] offset:8320
    ds_write_b128 v2, v[78:81] offset:12480
    ds_write_b128 v2, v[100:103] offset:16640
    ds_write_b128 v2, v[84:87] offset:20800
    ds_write_b128 v2, v[92:95] offset:24960
    ds_write_b128 v2, v[76:79] offset:29120
    s_cmp_eq_u32 s29, 3
    s_cbranch_scc0 C_G1
    s_mov_b64 exec, 1
    v_mov_b32 v28, 0
    s_mov_b32 s38, 0x40000
C_POLL:
    buffer_load_dword v30, v28, s[56:59], 0 offen offset:128 sc1
    s_waitcnt vmcnt(0)
    v_cmp_ne_u32 vcc, 1, v30
    s_cbranch_vccz C_PD
    s_sleep 2
    s_sub_u32 s38, s38, 1
    s_cmp_lg_u32 s38, 0
    s_cbranch_scc1 C_POLL
C_PD:
    s_mov_b64 exec, -1
C_G1:
    s_waitcnt lgkmcnt(0)
    s_barrier
    buffer_load_dwordx4 v[8:11], v1, s[4:7], s19 offen sc1
    buffer_load_dwordx4 v[12:15], v1, s[4:7], s19 offen offset:16 sc1
    buffer_load_dword v28, v4, s[4:7], s17 offen sc1
    buffer_load_dword v29, v4, s[4:7], s22 offen sc1
    buffer_load_dword v30, v4, s[4:7], s23 offen sc1
    ds_read_b128 v[76:79], v68 offset:3648
    ds_read_b128 v[80:83], v68 offset:3136
    ds_read_b128 v[84:87], v68 offset:2624
    ds_read_b128 v[88:91], v68 offset:2112
    ds_read_b128 v[92:95], v68 offset:1600
    ds_read_b128 v[96:99], v68 offset:1088
    ds_read_b128 v[100:103], v68 offset:576
    ds_read_b128 v[104:107], v68 offset:64
    s_waitcnt vmcnt(0)
    v_add_f32 v72, 1.0, v29
    v_cvt_pk_bf16_f32 v72, v72, v72
    v_and_b32 v72, 0xffff0000, v72
    v_readfirstlane_b32 s26, v30
    v_lshlrev_b32 v16, 16, v8
    v_lshlrev_b32 v17, 16, v9
    v_lshlrev_b32 v18, 16, v10
    v_lshlrev_b32 v19, 16, v11
    v_lshlrev_b32 v20, 16, v12
    v_lshlrev_b32 v21, 16, v13
    v_lshlrev_b32 v22, 16, v14
    v_lshlrev_b32 v23, 16, v15
    v_mul_f32 v16, v16, v72
    v_mul_f32 v17, v17, v72
    v_mul_f32 v18, v18, v72
    v_mul_f32 v19, v19, v72
    v_mul_f32 v20, v20, v72
    v_mul_f32 v21, v21, v72
    v_mul_f32 v22, v22, v72
    v_mul_f32 v23, v23, v72
    v_cvt_pk_bf16_f32 v24, v16, v17
    v_lshlrev_b32 v16, 16, v24
    v_and_b32 v17, 0xffff0000, v24
    v_cvt_pk_bf16_f32 v24, v18, v19
    v_lshlrev_b32 v18, 16, v24
    v_and_b32 v19, 0xffff0000, v24
    v_cvt_pk_bf16_f32 v24, v20, v21
    v_lshlrev_b32 v20, 16, v24
    v_and_b32 v21, 0xffff0000, v24
    v_cvt_pk_bf16_f32 v24, v22, v23
    v_lshlrev_b32 v22, 16, v24
    v_and_b32 v23, 0xffff0000, v24
    v_add_f32 v16, v28, v16
    v_add_f32 v17, v28, v17
    v_add_f32 v18, v28, v18
    v_add_f32 v19, v28, v19
    v_add_f32 v20, v28, v20
    v_add_f32 v21, v28, v21
    v_add_f32 v22, v28, v22
    v_add_f32 v23, v28, v23
    v_cvt_pk_bf16_f32 v24, v16, v17
    v_cvt_pk_bf16_f32 v25, v18, v19
    v_cvt_pk_bf16_f32 v26, v20, v21
    v_cvt_pk_bf16_f32 v27, v22, v23
    ds_write_b128 v2, v[24:27] offset:33760
    s_waitcnt lgkmcnt(0)
    s_barrier
    ds_read_b128 v[108:111], v69 offset:64
    ds_read_b128 v[112:115], v69 offset:576
    ds_read_b128 v[116:119], v69 offset:1088
    ds_read_b128 v[120:123], v69 offset:1600
    ds_read_b128 v[124:127], v69 offset:2112
    ds_read_b128 v[128:131], v69 offset:2624
    ds_read_b128 v[132:135], v69 offset:3136
    ds_read_b128 v[136:139], v69 offset:3648
    s_waitcnt lgkmcnt(7)
    v_mfma_f32_16x16x32_bf16 v[32:35], v[76:79], v[108:111], 0
    s_waitcnt lgkmcnt(6)
    v_mfma_f32_16x16x32_bf16 v[36:39], v[76:79], v[112:115], 0
    v_mfma_f32_16x16x32_bf16 v[36:39], v[80:83], v[108:111], v[36:39]
    v_mfma_f32_16x16x32_bf16 v[40:43], v[80:83], v[112:115], 0
    s_waitcnt lgkmcnt(5)
    v_mfma_f32_16x16x32_bf16 v[40:43], v[76:79], v[116:119], v[40:43]
    v_mfma_f32_16x16x32_bf16 v[44:47], v[80:83], v[116:119], 0
    v_mfma_f32_16x16x32_bf16 v[40:43], v[84:87], v[108:111], v[40:43]
    v_mfma_f32_16x16x32_bf16 v[44:47], v[84:87], v[112:115], v[44:47]
    v_mfma_f32_16x16x32_bf16 v[48:51], v[84:87], v[116:119], 0
    s_waitcnt lgkmcnt(4)
    v_mfma_f32_16x16x32_bf16 v[44:47], v[76:79], v[120:123], v[44:47]
    v_mfma_f32_16x16x32_bf16 v[48:51], v[80:83], v[120:123], v[48:51]
    v_mfma_f32_16x16x32_bf16 v[52:55], v[84:87], v[120:123], 0
    v_mfma_f32_16x16x32_bf16 v[44:47], v[88:91], v[108:111], v[44:47]
    v_mfma_f32_16x16x32_bf16 v[48:51], v[88:91], v[112:115], v[48:51]
    v_mfma_f32_16x16x32_bf16 v[52:55], v[88:91], v[116:119], v[52:55]
    v_mfma_f32_16x16x32_bf16 v[56:59], v[88:91], v[120:123], 0
    s_waitcnt lgkmcnt(3)
    v_mfma_f32_16x16x32_bf16 v[48:51], v[76:79], v[124:127], v[48:51]
    v_mfma_f32_16x16x32_bf16 v[52:55], v[80:83], v[124:127], v[52:55]
    v_mfma_f32_16x16x32_bf16 v[56:59], v[84:87], v[124:127], v[56:59]
    v_mfma_f32_16x16x32_bf16 v[60:63], v[88:91], v[124:127], 0
    v_mfma_f32_16x16x32_bf16 v[48:51], v[92:95], v[108:111], v[48:51]
    v_mfma_f32_16x16x32_bf16 v[52:55], v[92:95], v[112:115], v[52:55]
    v_mfma_f32_16x16x32_bf16 v[56:59], v[92:95], v[116:119], v[56:59]
    v_mfma_f32_16x16x32_bf16 v[60:63], v[92:95], v[120:123], v[60:63]
    s_waitcnt lgkmcnt(2)
    v_mfma_f32_16x16x32_bf16 v[52:55], v[76:79], v[128:131], v[52:55]
    v_mfma_f32_16x16x32_bf16 v[56:59], v[80:83], v[128:131], v[56:59]
    v_mfma_f32_16x16x32_bf16 v[60:63], v[84:87], v[128:131], v[60:63]
    v_mfma_f32_16x16x32_bf16 v[52:55], v[96:99], v[108:111], v[52:55]
    v_mfma_f32_16x16x32_bf16 v[56:59], v[96:99], v[112:115], v[56:59]
    v_mfma_f32_16x16x32_bf16 v[60:63], v[96:99], v[116:119], v[60:63]
    s_waitcnt lgkmcnt(1)
    v_mfma_f32_16x16x32_bf16 v[56:59], v[76:79], v[132:135], v[56:59]
    v_mfma_f32_16x16x32_bf16 v[60:63], v[80:83], v[132:135], v[60:63]
    v_mfma_f32_16x16x32_bf16 v[56:59], v[100:103], v[108:111], v[56:59]
    v_mfma_f32_16x16x32_bf16 v[60:63], v[100:103], v[112:115], v[60:63]
    s_waitcnt lgkmcnt(0)
    v_mfma_f32_16x16x32_bf16 v[60:63], v[76:79], v[136:139], v[60:63]
    v_mfma_f32_16x16x32_bf16 v[60:63], v[104:107], v[108:111], v[60:63]
    ds_read_b128 v[76:79], v68 offset:3584
    ds_read_b128 v[108:111], v69 offset:0
    ds_read_b128 v[80:83], v68 offset:3072
    ds_read_b128 v[112:115], v69 offset:512
    ds_read_b128 v[84:87], v68 offset:2560
    ds_read_b128 v[116:119], v69 offset:1024
    ds_read_b128 v[88:91], v68 offset:2048
    ds_read_b128 v[120:123], v69 offset:1536
    ds_read_b128 v[92:95], v68 offset:1536
    ds_read_b128 v[124:127], v69 offset:2048
    ds_read_b128 v[96:99], v68 offset:1024
    ds_read_b128 v[128:131], v69 offset:2560
    ds_read_b128 v[100:103], v68 offset:512
    ds_read_b128 v[132:135], v69 offset:3072
    ds_read_b128 v[104:107], v68 offset:0
    ds_read_b128 v[136:139], v69 offset:3584
    s_waitcnt lgkmcnt(14)
    v_mfma_f32_16x16x32_bf16 v[32:35], v[76:79], v[108:111], v[32:35]
    s_waitcnt lgkmcnt(12)
    v_mfma_f32_16x16x32_bf16 v[36:39], v[76:79], v[112:115], v[36:39]
    v_mfma_f32_16x16x32_bf16 v[36:39], v[80:83], v[108:111], v[36:39]
    v_mfma_f32_16x16x32_bf16 v[40:43], v[80:83], v[112:115], v[40:43]
    s_waitcnt lgkmcnt(10)
    v_mfma_f32_16x16x32_bf16 v[40:43], v[76:79], v[116:119], v[40:43]
    v_mfma_f32_16x16x32_bf16 v[44:47], v[80:83], v[116:119], v[44:47]
    v_mfma_f32_16x16x32_bf16 v[40:43], v[84:87], v[108:111], v[40:43]
    v_mfma_f32_16x16x32_bf16 v[44:47], v[84:87], v[112:115], v[44:47]
    v_mfma_f32_16x16x32_bf16 v[48:51], v[84:87], v[116:119], v[48:51]
    s_waitcnt lgkmcnt(8)
    v_mfma_f32_16x16x32_bf16 v[44:47], v[76:79], v[120:123], v[44:47]
    v_mfma_f32_16x16x32_bf16 v[48:51], v[80:83], v[120:123], v[48:51]
    v_mfma_f32_16x16x32_bf16 v[52:55], v[84:87], v[120:123], v[52:55]
    v_mfma_f32_16x16x32_bf16 v[44:47], v[88:91], v[108:111], v[44:47]
    v_mfma_f32_16x16x32_bf16 v[48:51], v[88:91], v[112:115], v[48:51]
    v_mfma_f32_16x16x32_bf16 v[52:55], v[88:91], v[116:119], v[52:55]
    v_mfma_f32_16x16x32_bf16 v[56:59], v[88:91], v[120:123], v[56:59]
    s_waitcnt lgkmcnt(6)
    v_mfma_f32_16x16x32_bf16 v[48:51], v[76:79], v[124:127], v[48:51]
    v_mfma_f32_16x16x32_bf16 v[52:55], v[80:83], v[124:127], v[52:55]
    v_mfma_f32_16x16x32_bf16 v[56:59], v[84:87], v[124:127], v[56:59]
    v_mfma_f32_16x16x32_bf16 v[60:63], v[88:91], v[124:127], v[60:63]
    v_mfma_f32_16x16x32_bf16 v[48:51], v[92:95], v[108:111], v[48:51]
    v_mfma_f32_16x16x32_bf16 v[52:55], v[92:95], v[112:115], v[52:55]
    v_mfma_f32_16x16x32_bf16 v[56:59], v[92:95], v[116:119], v[56:59]
    v_mfma_f32_16x16x32_bf16 v[60:63], v[92:95], v[120:123], v[60:63]
    s_waitcnt lgkmcnt(4)
    v_mfma_f32_16x16x32_bf16 v[52:55], v[76:79], v[128:131], v[52:55]
    v_mfma_f32_16x16x32_bf16 v[56:59], v[80:83], v[128:131], v[56:59]
    v_mfma_f32_16x16x32_bf16 v[60:63], v[84:87], v[128:131], v[60:63]
    v_mfma_f32_16x16x32_bf16 v[52:55], v[96:99], v[108:111], v[52:55]
    v_mfma_f32_16x16x32_bf16 v[56:59], v[96:99], v[112:115], v[56:59]
    v_mfma_f32_16x16x32_bf16 v[60:63], v[96:99], v[116:119], v[60:63]
    s_waitcnt lgkmcnt(2)
    v_mfma_f32_16x16x32_bf16 v[56:59], v[76:79], v[132:135], v[56:59]
    v_mfma_f32_16x16x32_bf16 v[60:63], v[80:83], v[132:135], v[60:63]
    v_mfma_f32_16x16x32_bf16 v[56:59], v[100:103], v[108:111], v[56:59]
    v_mfma_f32_16x16x32_bf16 v[60:63], v[100:103], v[112:115], v[60:63]
    s_waitcnt lgkmcnt(0)
    v_mfma_f32_16x16x32_bf16 v[60:63], v[76:79], v[136:139], v[60:63]
    v_mfma_f32_16x16x32_bf16 v[60:63], v[104:107], v[108:111], v[60:63]
    s_barrier
    s_nop 7
    ds_write_b128 v71, v[32:35] offset:0
    ds_write_b128 v71, v[36:39] offset:1024
    ds_write_b128 v71, v[40:43] offset:2048
    ds_write_b128 v71, v[44:47] offset:3072
    ds_write_b128 v71, v[48:51] offset:4096
    ds_write_b128 v71, v[52:55] offset:5120
    ds_write_b128 v71, v[56:59] offset:6144
    ds_write_b128 v71, v[60:63] offset:7168
    s_waitcnt lgkmcnt(0)
    s_barrier
    ds_read_b128 v[32:35], v1 offset:0
    ds_read_b128 v[36:39], v1 offset:16
    ds_read_b128 v[40:43], v1 offset:8192
    ds_read_b128 v[44:47], v1 offset:8208
    ds_read_b128 v[48:51], v1 offset:16384
    ds_read_b128 v[52:55], v1 offset:16400
    ds_read_b128 v[56:59], v1 offset:24576
    ds_read_b128 v[60:63], v1 offset:24592
    v_lshlrev_b32 v16, 16, v24
    v_and_b32 v17, 0xffff0000, v24
    v_lshlrev_b32 v18, 16, v25
    v_and_b32 v19, 0xffff0000, v25
    v_lshlrev_b32 v20, 16, v26
    v_and_b32 v21, 0xffff0000, v26
    v_lshlrev_b32 v22, 16, v27
    v_and_b32 v23, 0xffff0000, v27
    v_mul_f32 v16, s27, v16
    v_mul_f32 v17, s27, v17
    v_mul_f32 v18, s27, v18
    v_mul_f32 v19, s27, v19
    v_mul_f32 v20, s27, v20
    v_mul_f32 v21, s27, v21
    v_mul_f32 v22, s27, v22
    v_mul_f32 v23, s27, v23
    v_cvt_pk_bf16_f32 v28, v16, v17
    v_lshlrev_b32 v16, 16, v28
    v_and_b32 v17, 0xffff0000, v28
    v_cvt_pk_bf16_f32 v28, v18, v19
    v_lshlrev_b32 v18, 16, v28
    v_and_b32 v19, 0xffff0000, v28
    v_cvt_pk_bf16_f32 v28, v20, v21
    v_lshlrev_b32 v20, 16, v28
    v_and_b32 v21, 0xffff0000, v28
    v_cvt_pk_bf16_f32 v28, v22, v23
    v_lshlrev_b32 v22, 16, v28
    v_and_b32 v23, 0xffff0000, v28
    v_and_b32 v8, 0xffff0000, v8
    v_and_b32 v9, 0xffff0000, v9
    v_and_b32 v10, 0xffff0000, v10
    v_and_b32 v11, 0xffff0000, v11
    v_and_b32 v12, 0xffff0000, v12
    v_and_b32 v13, 0xffff0000, v13
    v_and_b32 v14, 0xffff0000, v14
    v_and_b32 v15, 0xffff0000, v15
    s_waitcnt lgkmcnt(0)
    v_add_f32 v32, v32, v40
    v_add_f32 v48, v48, v56
    v_add_f32 v33, v33, v41
    v_add_f32 v49, v49, v57
    v_add_f32 v34, v34, v42
    v_add_f32 v50, v50, v58
    v_add_f32 v35, v35, v43
    v_add_f32 v51, v51, v59
    v_add_f32 v36, v36, v44
    v_add_f32 v52, v52, v60
    v_add_f32 v37, v37, v45
    v_add_f32 v53, v53, v61
    v_add_f32 v38, v38, v46
    v_add_f32 v54, v54, v62
    v_add_f32 v39, v39, v47
    v_add_f32 v55, v55, v63
    v_add_f32 v32, v32, v48
    v_add_f32 v33, v33, v49
    v_add_f32 v34, v34, v50
    v_add_f32 v35, v35, v51
    v_add_f32 v36, v36, v52
    v_add_f32 v37, v37, v53
    v_add_f32 v38, v38, v54
    v_add_f32 v39, v39, v55
    v_cvt_pk_bf16_f32 v28, v32, v33
    v_lshlrev_b32 v32, 16, v28
    v_and_b32 v33, 0xffff0000, v28
    v_cvt_pk_bf16_f32 v28, v34, v35
    v_lshlrev_b32 v34, 16, v28
    v_and_b32 v35, 0xffff0000, v28
    v_cvt_pk_bf16_f32 v28, v36, v37
    v_lshlrev_b32 v36, 16, v28
    v_and_b32 v37, 0xffff0000, v28
    v_cvt_pk_bf16_f32 v28, v38, v39
    v_lshlrev_b32 v38, 16, v28
    v_and_b32 v39, 0xffff0000, v28
    v_add_f32 v32, v32, v16
    v_add_f32 v33, v33, v17
    v_add_f32 v34, v34, v18
    v_add_f32 v35, v35, v19
    v_add_f32 v36, v36, v20
    v_add_f32 v37, v37, v21
    v_add_f32 v38, v38, v22
    v_add_f32 v39, v39, v23
    v_cvt_pk_bf16_f32 v28, v32, v33
    v_lshlrev_b32 v32, 16, v28
    v_and_b32 v33, 0xffff0000, v28
    v_cvt_pk_bf16_f32 v28, v34, v35
    v_lshlrev_b32 v34, 16, v28
    v_and_b32 v35, 0xffff0000, v28
    v_cvt_pk_bf16_f32 v28, v36, v37
    v_lshlrev_b32 v36, 16, v28
    v_and_b32 v37, 0xffff0000, v28
    v_cvt_pk_bf16_f32 v28, v38, v39
    v_lshlrev_b32 v38, 16, v28
    v_and_b32 v39, 0xffff0000, v28
    v_mul_f32 v32, s26, v32
    v_mul_f32 v33, s26, v33
    v_mul_f32 v34, s26, v34
    v_mul_f32 v35, s26, v35
    v_mul_f32 v36, s26, v36
    v_mul_f32 v37, s26, v37
    v_mul_f32 v38, s26, v38
    v_mul_f32 v39, s26, v39
    v_cvt_pk_bf16_f32 v28, v32, v33
    v_lshlrev_b32 v32, 16, v28
    v_and_b32 v33, 0xffff0000, v28
    v_cvt_pk_bf16_f32 v28, v34, v35
    v_lshlrev_b32 v34, 16, v28
    v_and_b32 v35, 0xffff0000, v28
    v_cvt_pk_bf16_f32 v28, v36, v37
    v_lshlrev_b32 v36, 16, v28
    v_and_b32 v37, 0xffff0000, v28
    v_cvt_pk_bf16_f32 v28, v38, v39
    v_lshlrev_b32 v38, 16, v28
    v_and_b32 v39, 0xffff0000, v28
    v_add_f32 v32, v32, v8
    v_add_f32 v33, v33, v9
    v_add_f32 v34, v34, v10
    v_add_f32 v35, v35, v11
    v_add_f32 v36, v36, v12
    v_add_f32 v37, v37, v13
    v_add_f32 v38, v38, v14
    v_add_f32 v39, v39, v15
    v_cvt_pk_bf16_f32 v24, v32, v33
    v_cvt_pk_bf16_f32 v25, v34, v35
    v_cvt_pk_bf16_f32 v26, v36, v37
    v_cvt_pk_bf16_f32 v27, v38, v39
    s_lshl_b32 s19, s16, 12
    s_add_u32 s19, s19, 0x10000
    buffer_store_dwordx4 v[24:27], v2, s[4:7], s19 offen
    s_endpgm
.globl ffn_kernel
.p2align 8
.type ffn_kernel,@function
ffn_kernel:
    s_load_dwordx2 s[4:5], s[0:1], 144
    s_mov_b32 s6, 0x2000000
    s_mov_b32 s7, 0x00020000
    s_load_dwordx2 s[8:9], s[0:1], 128
    s_mov_b32 s10, 0x200000
    s_mov_b32 s11, 0x00020000
    s_load_dwordx2 s[12:13], s[0:1], 104
    s_mov_b32 s14, 0x400
    s_mov_b32 s15, 0x00020000
    s_cmp_ge_u32 s2, 256
    s_cbranch_scc1 F_END
    s_and_b32 s16, s2, 7
    s_lshl_b32 s16, s16, 2
    s_bfe_u32 s17, s2, 0x20003
    s_add_u32 s16, s16, s17
    s_lshr_b32 s17, s2, 5
    v_lshrrev_b32 v1, 6, v0
    v_and_b32 v2, 63, v0
    v_lshlrev_b32 v8, 4, v2
    v_readfirstlane_b32 s18, v1
    v_and_b32 v3, 7, v0
    v_lshrrev_b32 v4, 3, v0
    v_lshlrev_b32 v5, 12, v4
    v_lshl_add_u32 v5, v3, 4, v5
    s_lshl_b32 s19, s16, 7
    s_add_u32 s19, s19, 0x10000
    s_mul_i32 s32, s18, 14
    s_mul_i32 s33, s17, 224
    s_add_u32 s33, s33, s32
    s_lshl_b32 s33, s33, 10
    s_add_u32 s34, s33, 0x3d0000
    s_add_u32 s35, s34, 114688
    s_mul_i32 s33, s16, 224
    s_add_u32 s33, s33, s32
    s_lshl_b32 s33, s33, 10
    s_add_u32 s36, s33, 0x600000
    s_add_u32 s37, s36, 114688
    s_waitcnt lgkmcnt(0)
    v_lshlrev_b32 v6, 6, v4
    v_and_b32 v7, 3, v3
    v_lshl_add_u32 v6, v7, 4, v6
    v_lshrrev_b32 v7, 2, v3
    v_lshl_add_u32 v6, v7, 15, v6
    s_mul_i32 s20, s17, 7
    s_add_u32 s20, s20, s18
    s_cmp_eq_u32 s18, 7
    s_cbranch_scc1 F_ST
    s_lshl_b32 s21, s20, 15
    s_add_u32 s21, s21, 0x210000
    buffer_load_dwordx4 v[176:179], v5, s[4:7], s19 offen
    s_add_u32 s19, s19, 0x40000
    buffer_load_dwordx4 v[180:183], v5, s[4:7], s19 offen
    s_add_u32 s19, s19, 0x40000
    buffer_load_dwordx4 v[48:51], v8, s[4:7], s21 offen offset:0
    buffer_load_dwordx4 v[52:55], v8, s[4:7], s21 offen offset:1024
    buffer_load_dwordx4 v[56:59], v8, s[4:7], s21 offen offset:2048
    buffer_load_dwordx4 v[60:63], v8, s[4:7], s21 offen offset:3072
    s_add_u32 s21, s21, 4096
    buffer_load_dwordx4 v[64:67], v8, s[4:7], s21 offen offset:0
    buffer_load_dwordx4 v[68:71], v8, s[4:7], s21 offen offset:1024
    buffer_load_dwordx4 v[72:75], v8, s[4:7], s21 offen offset:2048
    buffer_load_dwordx4 v[76:79], v8, s[4:7], s21 offen offset:3072
    s_add_u32 s21, s21, 4096
    buffer_load_dwordx4 v[184:187], v5, s[4:7], s19 offen
    s_add_u32 s19, s19, 0x40000
    buffer_load_dwordx4 v[188:191], v5, s[4:7], s19 offen
    s_add_u32 s19, s19, 0x40000
    buffer_load_dwordx4 v[80:83], v8, s[4:7], s21 offen offset:0
    buffer_load_dwordx4 v[84:87], v8, s[4:7], s21 offen offset:1024
    buffer_load_dwordx4 v[88:91], v8, s[4:7], s21 offen offset:2048
    buffer_load_dwordx4 v[92:95], v8, s[4:7], s21 offen offset:3072
    s_add_u32 s21, s21, 4096
    buffer_load_dwordx4 v[96:99], v8, s[4:7], s21 offen offset:0
    buffer_load_dwordx4 v[100:103], v8, s[4:7], s21 offen offset:1024
    buffer_load_dwordx4 v[104:107], v8, s[4:7], s21 offen offset:2048
    buffer_load_dwordx4 v[108:111], v8, s[4:7], s21 offen offset:3072
    s_add_u32 s21, s21, 4096
    buffer_load_dwordx4 v[192:195], v5, s[4:7], s19 offen
    s_add_u32 s19, s19, 0x40000
    buffer_load_dwordx4 v[196:199], v5, s[4:7], s19 offen
    s_add_u32 s19, s19, 0x40000
    buffer_load_dwordx4 v[112:115], v8, s[4:7], s21 offen offset:0
    buffer_load_dwordx4 v[116:119], v8, s[4:7], s21 offen offset:1024
    buffer_load_dwordx4 v[120:123], v8, s[4:7], s21 offen offset:2048
    buffer_load_dwordx4 v[124:127], v8, s[4:7], s21 offen offset:3072
    s_add_u32 s21, s21, 4096
    buffer_load_dwordx4 v[128:131], v8, s[4:7], s21 offen offset:0
    buffer_load_dwordx4 v[132:135], v8, s[4:7], s21 offen offset:1024
    buffer_load_dwordx4 v[136:139], v8, s[4:7], s21 offen offset:2048
    buffer_load_dwordx4 v[140:143], v8, s[4:7], s21 offen offset:3072
    s_add_u32 s21, s21, 4096
    buffer_load_dwordx4 v[200:203], v5, s[4:7], s19 offen
    s_add_u32 s19, s19, 0x40000
    buffer_load_dwordx4 v[204:207], v5, s[4:7], s19 offen
    s_add_u32 s19, s19, 0x40000
    buffer_load_dwordx4 v[144:147], v8, s[4:7], s21 offen offset:0
    buffer_load_dwordx4 v[148:151], v8, s[4:7], s21 offen offset:1024
    buffer_load_dwordx4 v[152:155], v8, s[4:7], s21 offen offset:2048
    buffer_load_dwordx4 v[156:159], v8, s[4:7], s21 offen offset:3072
    s_add_u32 s21, s21, 4096
    buffer_load_dwordx4 v[160:163], v8, s[4:7], s21 offen offset:0
    buffer_load_dwordx4 v[164:167], v8, s[4:7], s21 offen offset:1024
    buffer_load_dwordx4 v[168:171], v8, s[4:7], s21 offen offset:2048
    buffer_load_dwordx4 v[172:175], v8, s[4:7], s21 offen offset:3072
    s_add_u32 s21, s21, 4096
    v_lshrrev_b32 v9, 5, v2
    v_lshlrev_b32 v9, 4, v9
    s_lshl_b32 s21, s20, 7
    s_add_u32 s22, s21, 0x6000
    s_add_u32 s21, s21, 0x4000
    v_lshrrev_b32 v10, 5, v2
    v_lshlrev_b32 v10, 9, v10
    v_bfe_u32 v11, v2, 2, 2
    v_lshl_add_u32 v10, v11, 6, v10
    v_bfe_u32 v11, v2, 4, 1
    v_lshl_add_u32 v10, v11, 5, v10
    v_and_b32 v11, 3, v2
    v_lshl_add_u32 v10, v11, 3, v10
    s_waitcnt vmcnt(39)
    ds_write_b128 v6, v[176:179] offset:0
    s_waitcnt vmcnt(38)
    ds_write_b128 v6, v[180:183] offset:4096
    s_waitcnt lgkmcnt(0)
    s_barrier
    ds_read_b64_tr_b16 v[208:209], v10 offset:0
    ds_read_b64_tr_b16 v[210:211], v10 offset:256
    ds_read_b64_tr_b16 v[212:213], v10 offset:32768
    ds_read_b64_tr_b16 v[214:215], v10 offset:33024
    ds_read_b64_tr_b16 v[216:217], v10 offset:1024
    ds_read_b64_tr_b16 v[218:219], v10 offset:1280
    ds_read_b64_tr_b16 v[220:221], v10 offset:33792
    ds_read_b64_tr_b16 v[222:223], v10 offset:34048
    ds_read_b64_tr_b16 v[224:225], v10 offset:2048
    ds_read_b64_tr_b16 v[226:227], v10 offset:2304
    ds_read_b64_tr_b16 v[228:229], v10 offset:34816
    ds_read_b64_tr_b16 v[230:231], v10 offset:35072
    ds_read_b64_tr_b16 v[232:233], v10 offset:3072
    ds_read_b64_tr_b16 v[234:235], v10 offset:3328
    ds_read_b64_tr_b16 v[236:237], v10 offset:35840
    ds_read_b64_tr_b16 v[238:239], v10 offset:36096
    s_waitcnt vmcnt(37) lgkmcnt(12)
    v_mfma_f32_32x32x16_bf16 v[16:31], v[48:51], v[208:211], 0
    v_mfma_f32_32x32x16_bf16 v[32:47], v[48:51], v[212:215], 0
    ds_read_b64_tr_b16 v[208:209], v10 offset:4096
    ds_read_b64_tr_b16 v[210:211], v10 offset:4352
    ds_read_b64_tr_b16 v[212:213], v10 offset:36864
    ds_read_b64_tr_b16 v[214:215], v10 offset:37120
    s_waitcnt vmcnt(36) lgkmcnt(12)
    v_mfma_f32_32x32x16_bf16 v[16:31], v[52:55], v[216:219], v[16:31]
    v_mfma_f32_32x32x16_bf16 v[32:47], v[52:55], v[220:223], v[32:47]
    ds_read_b64_tr_b16 v[216:217], v10 offset:5120
    ds_read_b64_tr_b16 v[218:219], v10 offset:5376
    ds_read_b64_tr_b16 v[220:221], v10 offset:37888
    ds_read_b64_tr_b16 v[222:223], v10 offset:38144
    s_waitcnt vmcnt(35) lgkmcnt(12)
    v_mfma_f32_32x32x16_bf16 v[16:31], v[56:59], v[224:227], v[16:31]
    v_mfma_f32_32x32x16_bf16 v[32:47], v[56:59], v[228:231], v[32:47]
    ds_read_b64_tr_b16 v[224:225], v10 offset:6144
    ds_read_b64_tr_b16 v[226:227], v10 offset:6400
    ds_read_b64_tr_b16 v[228:229], v10 offset:38912
    ds_read_b64_tr_b16 v[230:231], v10 offset:39168
    s_waitcnt vmcnt(34) lgkmcnt(12)
    v_mfma_f32_32x32x16_bf16 v[16:31], v[60:63], v[232:235], v[16:31]
    v_mfma_f32_32x32x16_bf16 v[32:47], v[60:63], v[236:239], v[32:47]
    ds_read_b64_tr_b16 v[232:233], v10 offset:7168
    ds_read_b64_tr_b16 v[234:235], v10 offset:7424
    ds_read_b64_tr_b16 v[236:237], v10 offset:39936
    ds_read_b64_tr_b16 v[238:239], v10 offset:40192
    s_waitcnt vmcnt(33) lgkmcnt(12)
    v_mfma_f32_32x32x16_bf16 v[16:31], v[64:67], v[208:211], v[16:31]
    v_mfma_f32_32x32x16_bf16 v[32:47], v[64:67], v[212:215], v[32:47]
    s_waitcnt vmcnt(32) lgkmcnt(8)
    v_mfma_f32_32x32x16_bf16 v[16:31], v[68:71], v[216:219], v[16:31]
    v_mfma_f32_32x32x16_bf16 v[32:47], v[68:71], v[220:223], v[32:47]
    s_waitcnt vmcnt(29)
    ds_write_b128 v6, v[184:187] offset:8192
    s_waitcnt vmcnt(28)
    ds_write_b128 v6, v[188:191] offset:12288
    s_waitcnt vmcnt(31) lgkmcnt(6)
    v_mfma_f32_32x32x16_bf16 v[16:31], v[72:75], v[224:227], v[16:31]
    v_mfma_f32_32x32x16_bf16 v[32:47], v[72:75], v[228:231], v[32:47]
    s_waitcnt vmcnt(30) lgkmcnt(2)
    v_mfma_f32_32x32x16_bf16 v[16:31], v[76:79], v[232:235], v[16:31]
    v_mfma_f32_32x32x16_bf16 v[32:47], v[76:79], v[236:239], v[32:47]
    s_waitcnt lgkmcnt(0)
    s_barrier
    ds_read_b64_tr_b16 v[208:209], v10 offset:8192
    ds_read_b64_tr_b16 v[210:211], v10 offset:8448
    ds_read_b64_tr_b16 v[212:213], v10 offset:40960
    ds_read_b64_tr_b16 v[214:215], v10 offset:41216
    ds_read_b64_tr_b16 v[216:217], v10 offset:9216
    ds_read_b64_tr_b16 v[218:219], v10 offset:9472
    ds_read_b64_tr_b16 v[220:221], v10 offset:41984
    ds_read_b64_tr_b16 v[222:223], v10 offset:42240
    ds_read_b64_tr_b16 v[224:225], v10 offset:10240
    ds_read_b64_tr_b16 v[226:227], v10 offset:10496
    ds_read_b64_tr_b16 v[228:229], v10 offset:43008
    ds_read_b64_tr_b16 v[230:231], v10 offset:43264
    ds_read_b64_tr_b16 v[232:233], v10 offset:11264
    ds_read_b64_tr_b16 v[234:235], v10 offset:11520
    ds_read_b64_tr_b16 v[236:237], v10 offset:44032
    ds_read_b64_tr_b16 v[238:239], v10 offset:44288
    s_waitcnt vmcnt(27) lgkmcnt(12)
    v_mfma_f32_32x32x16_bf16 v[16:31], v[80:83], v[208:211], v[16:31]
    v_mfma_f32_32x32x16_bf16 v[32:47], v[80:83], v[212:215], v[32:47]
    ds_read_b64_tr_b16 v[208:209], v10 offset:12288
    ds_read_b64_tr_b16 v[210:211], v10 offset:12544
    ds_read_b64_tr_b16 v[212:213], v10 offset:45056
    ds_read_b64_tr_b16 v[214:215], v10 offset:45312
    s_waitcnt vmcnt(26) lgkmcnt(12)
    v_mfma_f32_32x32x16_bf16 v[16:31], v[84:87], v[216:219], v[16:31]
    v_mfma_f32_32x32x16_bf16 v[32:47], v[84:87], v[220:223], v[32:47]
    ds_read_b64_tr_b16 v[216:217], v10 offset:13312
    ds_read_b64_tr_b16 v[218:219], v10 offset:13568
    ds_read_b64_tr_b16 v[220:221], v10 offset:46080
    ds_read_b64_tr_b16 v[222:223], v10 offset:46336
    s_waitcnt vmcnt(25) lgkmcnt(12)
    v_mfma_f32_32x32x16_bf16 v[16:31], v[88:91], v[224:227], v[16:31]
    v_mfma_f32_32x32x16_bf16 v[32:47], v[88:91], v[228:231], v[32:47]
    ds_read_b64_tr_b16 v[224:225], v10 offset:14336
    ds_read_b64_tr_b16 v[226:227], v10 offset:14592
    ds_read_b64_tr_b16 v[228:229], v10 offset:47104
    ds_read_b64_tr_b16 v[230:231], v10 offset:47360
    s_waitcnt vmcnt(24) lgkmcnt(12)
    v_mfma_f32_32x32x16_bf16 v[16:31], v[92:95], v[232:235], v[16:31]
    v_mfma_f32_32x32x16_bf16 v[32:47], v[92:95], v[236:239], v[32:47]
    ds_read_b64_tr_b16 v[232:233], v10 offset:15360
    ds_read_b64_tr_b16 v[234:235], v10 offset:15616
    ds_read_b64_tr_b16 v[236:237], v10 offset:48128
    ds_read_b64_tr_b16 v[238:239], v10 offset:48384
    s_waitcnt vmcnt(23) lgkmcnt(12)
    v_mfma_f32_32x32x16_bf16 v[16:31], v[96:99], v[208:211], v[16:31]
    v_mfma_f32_32x32x16_bf16 v[32:47], v[96:99], v[212:215], v[32:47]
    s_waitcnt vmcnt(22) lgkmcnt(8)
    v_mfma_f32_32x32x16_bf16 v[16:31], v[100:103], v[216:219], v[16:31]
    v_mfma_f32_32x32x16_bf16 v[32:47], v[100:103], v[220:223], v[32:47]
    s_waitcnt vmcnt(19)
    ds_write_b128 v6, v[192:195] offset:16384
    s_waitcnt vmcnt(18)
    ds_write_b128 v6, v[196:199] offset:20480
    s_waitcnt vmcnt(21) lgkmcnt(6)
    v_mfma_f32_32x32x16_bf16 v[16:31], v[104:107], v[224:227], v[16:31]
    v_mfma_f32_32x32x16_bf16 v[32:47], v[104:107], v[228:231], v[32:47]
    buffer_load_dwordx4 v[48:51], v8, s[4:7], s34 offen offset:0
    buffer_load_dwordx4 v[52:55], v8, s[4:7], s35 offen offset:0
    s_waitcnt vmcnt(22) lgkmcnt(2)
    v_mfma_f32_32x32x16_bf16 v[16:31], v[108:111], v[232:235], v[16:31]
    v_mfma_f32_32x32x16_bf16 v[32:47], v[108:111], v[236:239], v[32:47]
    buffer_load_dwordx4 v[56:59], v8, s[4:7], s34 offen offset:1024
    buffer_load_dwordx4 v[60:63], v8, s[4:7], s35 offen offset:1024
    s_waitcnt lgkmcnt(0)
    s_barrier
    ds_read_b64_tr_b16 v[208:209], v10 offset:16384
    ds_read_b64_tr_b16 v[210:211], v10 offset:16640
    ds_read_b64_tr_b16 v[212:213], v10 offset:49152
    ds_read_b64_tr_b16 v[214:215], v10 offset:49408
    ds_read_b64_tr_b16 v[216:217], v10 offset:17408
    ds_read_b64_tr_b16 v[218:219], v10 offset:17664
    ds_read_b64_tr_b16 v[220:221], v10 offset:50176
    ds_read_b64_tr_b16 v[222:223], v10 offset:50432
    ds_read_b64_tr_b16 v[224:225], v10 offset:18432
    ds_read_b64_tr_b16 v[226:227], v10 offset:18688
    ds_read_b64_tr_b16 v[228:229], v10 offset:51200
    ds_read_b64_tr_b16 v[230:231], v10 offset:51456
    ds_read_b64_tr_b16 v[232:233], v10 offset:19456
    ds_read_b64_tr_b16 v[234:235], v10 offset:19712
    ds_read_b64_tr_b16 v[236:237], v10 offset:52224
    ds_read_b64_tr_b16 v[238:239], v10 offset:52480
    s_waitcnt vmcnt(21) lgkmcnt(12)
    v_mfma_f32_32x32x16_bf16 v[16:31], v[112:115], v[208:211], v[16:31]
    v_mfma_f32_32x32x16_bf16 v[32:47], v[112:115], v[212:215], v[32:47]
    buffer_load_dwordx4 v[64:67], v8, s[4:7], s34 offen offset:2048
    buffer_load_dwordx4 v[68:71], v8, s[4:7], s35 offen offset:2048
    ds_read_b64_tr_b16 v[208:209], v10 offset:20480
    ds_read_b64_tr_b16 v[210:211], v10 offset:20736
    ds_read_b64_tr_b16 v[212:213], v10 offset:53248
    ds_read_b64_tr_b16 v[214:215], v10 offset:53504
    s_waitcnt vmcnt(22) lgkmcnt(12)
    v_mfma_f32_32x32x16_bf16 v[16:31], v[116:119], v[216:219], v[16:31]
    v_mfma_f32_32x32x16_bf16 v[32:47], v[116:119], v[220:223], v[32:47]
    buffer_load_dwordx4 v[72:75], v8, s[4:7], s34 offen offset:3072
    buffer_load_dwordx4 v[76:79], v8, s[4:7], s35 offen offset:3072
    s_add_u32 s34, s34, 4096
    s_add_u32 s35, s35, 4096
    ds_read_b64_tr_b16 v[216:217], v10 offset:21504
    ds_read_b64_tr_b16 v[218:219], v10 offset:21760
    ds_read_b64_tr_b16 v[220:221], v10 offset:54272
    ds_read_b64_tr_b16 v[222:223], v10 offset:54528
    s_waitcnt vmcnt(23) lgkmcnt(12)
    v_mfma_f32_32x32x16_bf16 v[16:31], v[120:123], v[224:227], v[16:31]
    v_mfma_f32_32x32x16_bf16 v[32:47], v[120:123], v[228:231], v[32:47]
    buffer_load_dwordx4 v[80:83], v8, s[4:7], s34 offen offset:0
    buffer_load_dwordx4 v[84:87], v8, s[4:7], s35 offen offset:0
    ds_read_b64_tr_b16 v[224:225], v10 offset:22528
    ds_read_b64_tr_b16 v[226:227], v10 offset:22784
    ds_read_b64_tr_b16 v[228:229], v10 offset:55296
    ds_read_b64_tr_b16 v[230:231], v10 offset:55552
    s_waitcnt vmcnt(24) lgkmcnt(12)
    v_mfma_f32_32x32x16_bf16 v[16:31], v[124:127], v[232:235], v[16:31]
    v_mfma_f32_32x32x16_bf16 v[32:47], v[124:127], v[236:239], v[32:47]
    buffer_load_dwordx4 v[88:91], v8, s[4:7], s34 offen offset:1024
    buffer_load_dwordx4 v[92:95], v8, s[4:7], s35 offen offset:1024
    ds_read_b64_tr_b16 v[232:233], v10 offset:23552
    ds_read_b64_tr_b16 v[234:235], v10 offset:23808
    ds_read_b64_tr_b16 v[236:237], v10 offset:56320
    ds_read_b64_tr_b16 v[238:239], v10 offset:56576
    s_waitcnt vmcnt(25) lgkmcnt(12)
    v_mfma_f32_32x32x16_bf16 v[16:31], v[128:131], v[208:211], v[16:31]
    v_mfma_f32_32x32x16_bf16 v[32:47], v[128:131], v[212:215], v[32:47]
    buffer_load_dwordx4 v[96:99], v8, s[4:7], s34 offen offset:2048
    buffer_load_dwordx4 v[100:103], v8, s[4:7], s35 offen offset:2048
    s_waitcnt vmcnt(26) lgkmcnt(8)
    v_mfma_f32_32x32x16_bf16 v[16:31], v[132:135], v[216:219], v[16:31]
    v_mfma_f32_32x32x16_bf16 v[32:47], v[132:135], v[220:223], v[32:47]
    buffer_load_dwordx4 v[104:107], v8, s[4:7], s34 offen offset:3072
    buffer_load_dwordx4 v[108:111], v8, s[4:7], s35 offen offset:3072
    s_add_u32 s34, s34, 4096
    s_add_u32 s35, s35, 4096
    s_waitcnt vmcnt(25)
    ds_write_b128 v6, v[200:203] offset:24576
    s_waitcnt vmcnt(24)
    ds_write_b128 v6, v[204:207] offset:28672
    s_waitcnt vmcnt(27) lgkmcnt(6)
    v_mfma_f32_32x32x16_bf16 v[16:31], v[136:139], v[224:227], v[16:31]
    v_mfma_f32_32x32x16_bf16 v[32:47], v[136:139], v[228:231], v[32:47]
    buffer_load_dwordx4 v[112:115], v8, s[4:7], s34 offen offset:0
    buffer_load_dwordx4 v[116:119], v8, s[4:7], s35 offen offset:0
    s_waitcnt vmcnt(28) lgkmcnt(2)
    v_mfma_f32_32x32x16_bf16 v[16:31], v[140:143], v[232:235], v[16:31]
    v_mfma_f32_32x32x16_bf16 v[32:47], v[140:143], v[236:239], v[32:47]
    buffer_load_dwordx4 v[120:123], v8, s[4:7], s34 offen offset:1024
    buffer_load_dwordx4 v[124:127], v8, s[4:7], s35 offen offset:1024
    s_waitcnt lgkmcnt(0)
    s_barrier
    buffer_load_dwordx4 v[176:179], v9, s[4:7], s21 offen offset:0
    buffer_load_dwordx4 v[192:195], v9, s[4:7], s22 offen offset:0
    buffer_load_dwordx4 v[180:183], v9, s[4:7], s21 offen offset:32
    buffer_load_dwordx4 v[196:199], v9, s[4:7], s22 offen offset:32
    buffer_load_dwordx4 v[184:187], v9, s[4:7], s21 offen offset:64
    buffer_load_dwordx4 v[200:203], v9, s[4:7], s22 offen offset:64
    buffer_load_dwordx4 v[188:191], v9, s[4:7], s21 offen offset:96
    buffer_load_dwordx4 v[204:207], v9, s[4:7], s22 offen offset:96
    ds_read_b64_tr_b16 v[208:209], v10 offset:24576
    ds_read_b64_tr_b16 v[210:211], v10 offset:24832
    ds_read_b64_tr_b16 v[212:213], v10 offset:57344
    ds_read_b64_tr_b16 v[214:215], v10 offset:57600
    ds_read_b64_tr_b16 v[216:217], v10 offset:25600
    ds_read_b64_tr_b16 v[218:219], v10 offset:25856
    ds_read_b64_tr_b16 v[220:221], v10 offset:58368
    ds_read_b64_tr_b16 v[222:223], v10 offset:58624
    ds_read_b64_tr_b16 v[224:225], v10 offset:26624
    ds_read_b64_tr_b16 v[226:227], v10 offset:26880
    ds_read_b64_tr_b16 v[228:229], v10 offset:59392
    ds_read_b64_tr_b16 v[230:231], v10 offset:59648
    ds_read_b64_tr_b16 v[232:233], v10 offset:27648
    ds_read_b64_tr_b16 v[234:235], v10 offset:27904
    ds_read_b64_tr_b16 v[236:237], v10 offset:60416
    ds_read_b64_tr_b16 v[238:239], v10 offset:60672
    s_waitcnt vmcnt(35) lgkmcnt(12)
    v_mfma_f32_32x32x16_bf16 v[16:31], v[144:147], v[208:211], v[16:31]
    v_mfma_f32_32x32x16_bf16 v[32:47], v[144:147], v[212:215], v[32:47]
    buffer_load_dwordx4 v[128:131], v8, s[4:7], s34 offen offset:2048
    buffer_load_dwordx4 v[132:135], v8, s[4:7], s35 offen offset:2048
    ds_read_b64_tr_b16 v[208:209], v10 offset:28672
    ds_read_b64_tr_b16 v[210:211], v10 offset:28928
    ds_read_b64_tr_b16 v[212:213], v10 offset:61440
    ds_read_b64_tr_b16 v[214:215], v10 offset:61696
    s_waitcnt vmcnt(36) lgkmcnt(12)
    v_mfma_f32_32x32x16_bf16 v[16:31], v[148:151], v[216:219], v[16:31]
    v_mfma_f32_32x32x16_bf16 v[32:47], v[148:151], v[220:223], v[32:47]
    buffer_load_dwordx4 v[136:139], v8, s[4:7], s34 offen offset:3072
    buffer_load_dwordx4 v[140:143], v8, s[4:7], s35 offen offset:3072
    s_add_u32 s34, s34, 4096
    s_add_u32 s35, s35, 4096
    ds_read_b64_tr_b16 v[216:217], v10 offset:29696
    ds_read_b64_tr_b16 v[218:219], v10 offset:29952
    ds_read_b64_tr_b16 v[220:221], v10 offset:62464
    ds_read_b64_tr_b16 v[222:223], v10 offset:62720
    s_waitcnt vmcnt(37) lgkmcnt(12)
    v_mfma_f32_32x32x16_bf16 v[16:31], v[152:155], v[224:227], v[16:31]
    v_mfma_f32_32x32x16_bf16 v[32:47], v[152:155], v[228:231], v[32:47]
    buffer_load_dwordx4 v[144:147], v8, s[4:7], s34 offen offset:0
    buffer_load_dwordx4 v[148:151], v8, s[4:7], s35 offen offset:0
    ds_read_b64_tr_b16 v[224:225], v10 offset:30720
    ds_read_b64_tr_b16 v[226:227], v10 offset:30976
    ds_read_b64_tr_b16 v[228:229], v10 offset:63488
    ds_read_b64_tr_b16 v[230:231], v10 offset:63744
    s_waitcnt vmcnt(38) lgkmcnt(12)
    v_mfma_f32_32x32x16_bf16 v[16:31], v[156:159], v[232:235], v[16:31]
    v_mfma_f32_32x32x16_bf16 v[32:47], v[156:159], v[236:239], v[32:47]
    ds_read_b64_tr_b16 v[232:233], v10 offset:31744
    ds_read_b64_tr_b16 v[234:235], v10 offset:32000
    ds_read_b64_tr_b16 v[236:237], v10 offset:64512
    ds_read_b64_tr_b16 v[238:239], v10 offset:64768
    s_waitcnt vmcnt(37) lgkmcnt(12)
    v_mfma_f32_32x32x16_bf16 v[16:31], v[160:163], v[208:211], v[16:31]
    v_mfma_f32_32x32x16_bf16 v[32:47], v[160:163], v[212:215], v[32:47]
    s_waitcnt vmcnt(36) lgkmcnt(8)
    v_mfma_f32_32x32x16_bf16 v[16:31], v[164:167], v[216:219], v[16:31]
    v_mfma_f32_32x32x16_bf16 v[32:47], v[164:167], v[220:223], v[32:47]
    s_waitcnt vmcnt(35) lgkmcnt(4)
    v_mfma_f32_32x32x16_bf16 v[16:31], v[168:171], v[224:227], v[16:31]
    v_mfma_f32_32x32x16_bf16 v[32:47], v[168:171], v[228:231], v[32:47]
    s_waitcnt vmcnt(34) lgkmcnt(0)
    v_mfma_f32_32x32x16_bf16 v[16:31], v[172:175], v[232:235], v[16:31]
    v_mfma_f32_32x32x16_bf16 v[32:47], v[172:175], v[236:239], v[32:47]
    s_barrier
    v_and_b32 v11, 31, v2
    v_lshlrev_b32 v11, 3, v11
    v_add_u32 v11, 0x10000, v11
    ds_read_b64 v[12:13], v11
    ds_read_b64 v[14:15], v11 offset:256
    s_mul_i32 s21, s16, 224
    s_lshl_b32 s22, s20, 1
    s_add_u32 s21, s21, s22
    s_lshl_b32 s21, s21, 10
    s_add_u32 s21, s21, 0x600000
    s_add_u32 s22, s21, 114688
    s_waitcnt vmcnt(6) lgkmcnt(0)
    s_nop 4
    v_fma_f32 v16, -v12, v176, v16
    v_fma_f32 v17, -v12, v177, v17
    v_fma_f32 v18, -v12, v178, v18
    v_fma_f32 v19, -v12, v179, v19
    v_fma_f32 v20, -v12, v180, v20
    v_fma_f32 v21, -v12, v181, v21
    v_fma_f32 v22, -v12, v182, v22
    v_fma_f32 v23, -v12, v183, v23
    v_fma_f32 v24, -v12, v184, v24
    v_fma_f32 v25, -v12, v185, v25
    v_fma_f32 v26, -v12, v186, v26
    v_fma_f32 v27, -v12, v187, v27
    v_fma_f32 v28, -v12, v188, v28
    v_fma_f32 v29, -v12, v189, v29
    v_fma_f32 v30, -v12, v190, v30
    v_fma_f32 v31, -v12, v191, v31
    v_fma_f32 v16, v16, v13, v192
    v_fma_f32 v17, v17, v13, v193
    v_fma_f32 v18, v18, v13, v194
    v_fma_f32 v19, v19, v13, v195
    v_fma_f32 v20, v20, v13, v196
    v_fma_f32 v21, v21, v13, v197
    v_fma_f32 v22, v22, v13, v198
    v_fma_f32 v23, v23, v13, v199
    v_fma_f32 v24, v24, v13, v200
    v_fma_f32 v25, v25, v13, v201
    v_fma_f32 v26, v26, v13, v202
    v_fma_f32 v27, v27, v13, v203
    v_fma_f32 v28, v28, v13, v204
    v_fma_f32 v29, v29, v13, v205
    v_fma_f32 v30, v30, v13, v206
    v_fma_f32 v31, v31, v13, v207
    v_max_f32 v16, 0, v16
    v_max_f32 v17, 0, v17
    v_max_f32 v18, 0, v18
    v_max_f32 v19, 0, v19
    v_max_f32 v20, 0, v20
    v_max_f32 v21, 0, v21
    v_max_f32 v22, 0, v22
    v_max_f32 v23, 0, v23
    v_max_f32 v24, 0, v24
    v_max_f32 v25, 0, v25
    v_max_f32 v26, 0, v26
    v_max_f32 v27, 0, v27
    v_max_f32 v28, 0, v28
    v_max_f32 v29, 0, v29
    v_max_f32 v30, 0, v30
    v_max_f32 v31, 0, v31
    v_mul_f32 v16, v16, v16
    v_mul_f32 v17, v17, v17
    v_mul_f32 v18, v18, v18
    v_mul_f32 v19, v19, v19
    v_mul_f32 v20, v20, v20
    v_mul_f32 v21, v21, v21
    v_mul_f32 v22, v22, v22
    v_mul_f32 v23, v23, v23
    v_mul_f32 v24, v24, v24
    v_mul_f32 v25, v25, v25
    v_mul_f32 v26, v26, v26
    v_mul_f32 v27, v27, v27
    v_mul_f32 v28, v28, v28
    v_mul_f32 v29, v29, v29
    v_mul_f32 v30, v30, v30
    v_mul_f32 v31, v31, v31
    v_cvt_pk_bf16_f32 v160, v16, v17
    v_cvt_pk_bf16_f32 v161, v18, v19
    v_cvt_pk_bf16_f32 v162, v20, v21
    v_cvt_pk_bf16_f32 v163, v22, v23
    v_cvt_pk_bf16_f32 v164, v24, v25
    v_cvt_pk_bf16_f32 v165, v26, v27
    v_cvt_pk_bf16_f32 v166, v28, v29
    v_cvt_pk_bf16_f32 v167, v30, v31
    buffer_store_dwordx4 v[160:163], v8, s[4:7], s21 offen sc1
    buffer_store_dwordx4 v[164:167], v8, s[4:7], s21 offen offset:1024 sc1
    v_fma_f32 v32, -v14, v176, v32
    v_fma_f32 v33, -v14, v177, v33
    v_fma_f32 v34, -v14, v178, v34
    v_fma_f32 v35, -v14, v179, v35
    v_fma_f32 v36, -v14, v180, v36
    v_fma_f32 v37, -v14, v181, v37
    v_fma_f32 v38, -v14, v182, v38
    v_fma_f32 v39, -v14, v183, v39
    v_fma_f32 v40, -v14, v184, v40
    v_fma_f32 v41, -v14, v185, v41
    v_fma_f32 v42, -v14, v186, v42
    v_fma_f32 v43, -v14, v187, v43
    v_fma_f32 v44, -v14, v188, v44
    v_fma_f32 v45, -v14, v189, v45
    v_fma_f32 v46, -v14, v190, v46
    v_fma_f32 v47, -v14, v191, v47
    v_fma_f32 v32, v32, v15, v192
    v_fma_f32 v33, v33, v15, v193
    v_fma_f32 v34, v34, v15, v194
    v_fma_f32 v35, v35, v15, v195
    v_fma_f32 v36, v36, v15, v196
    v_fma_f32 v37, v37, v15, v197
    v_fma_f32 v38, v38, v15, v198
    v_fma_f32 v39, v39, v15, v199
    v_fma_f32 v40, v40, v15, v200
    v_fma_f32 v41, v41, v15, v201
    v_fma_f32 v42, v42, v15, v202
    v_fma_f32 v43, v43, v15, v203
    v_fma_f32 v44, v44, v15, v204
    v_fma_f32 v45, v45, v15, v205
    v_fma_f32 v46, v46, v15, v206
    v_fma_f32 v47, v47, v15, v207
    v_max_f32 v32, 0, v32
    v_max_f32 v33, 0, v33
    v_max_f32 v34, 0, v34
    v_max_f32 v35, 0, v35
    v_max_f32 v36, 0, v36
    v_max_f32 v37, 0, v37
    v_max_f32 v38, 0, v38
    v_max_f32 v39, 0, v39
    v_max_f32 v40, 0, v40
    v_max_f32 v41, 0, v41
    v_max_f32 v42, 0, v42
    v_max_f32 v43, 0, v43
    v_max_f32 v44, 0, v44
    v_max_f32 v45, 0, v45
    v_max_f32 v46, 0, v46
    v_max_f32 v47, 0, v47
    v_mul_f32 v32, v32, v32
    v_mul_f32 v33, v33, v33
    v_mul_f32 v34, v34, v34
    v_mul_f32 v35, v35, v35
    v_mul_f32 v36, v36, v36
    v_mul_f32 v37, v37, v37
    v_mul_f32 v38, v38, v38
    v_mul_f32 v39, v39, v39
    v_mul_f32 v40, v40, v40
    v_mul_f32 v41, v41, v41
    v_mul_f32 v42, v42, v42
    v_mul_f32 v43, v43, v43
    v_mul_f32 v44, v44, v44
    v_mul_f32 v45, v45, v45
    v_mul_f32 v46, v46, v46
    v_mul_f32 v47, v47, v47
    v_cvt_pk_bf16_f32 v168, v32, v33
    v_cvt_pk_bf16_f32 v169, v34, v35
    v_cvt_pk_bf16_f32 v170, v36, v37
    v_cvt_pk_bf16_f32 v171, v38, v39
    v_cvt_pk_bf16_f32 v172, v40, v41
    v_cvt_pk_bf16_f32 v173, v42, v43
    v_cvt_pk_bf16_f32 v174, v44, v45
    v_cvt_pk_bf16_f32 v175, v46, v47
    buffer_store_dwordx4 v[168:171], v8, s[4:7], s22 offen sc1
    buffer_store_dwordx4 v[172:175], v8, s[4:7], s22 offen offset:1024 sc1
    buffer_load_dwordx4 v[152:155], v8, s[4:7], s34 offen offset:1024
    buffer_load_dwordx4 v[156:159], v8, s[4:7], s35 offen offset:1024
    s_waitcnt vmcnt(2)
    s_barrier
F_P2:
    s_barrier
F_GO:
    buffer_load_dwordx4 v[16:19], v8, s[4:7], s36 offen offset:0 sc1
    buffer_load_dwordx4 v[20:23], v8, s[4:7], s37 offen offset:0 sc1
    buffer_load_dwordx4 v[24:27], v8, s[4:7], s36 offen offset:1024 sc1
    buffer_load_dwordx4 v[28:31], v8, s[4:7], s37 offen offset:1024 sc1
    buffer_load_dwordx4 v[32:35], v8, s[4:7], s36 offen offset:2048 sc1
    buffer_load_dwordx4 v[36:39], v8, s[4:7], s37 offen offset:2048 sc1
    buffer_load_dwordx4 v[40:43], v8, s[4:7], s36 offen offset:3072 sc1
    buffer_load_dwordx4 v[44:47], v8, s[4:7], s37 offen offset:3072 sc1
    s_add_u32 s36, s36, 4096
    s_add_u32 s37, s37, 4096
    buffer_load_dwordx4 v[160:163], v8, s[4:7], s36 offen offset:0 sc1
    buffer_load_dwordx4 v[164:167], v8, s[4:7], s37 offen offset:0 sc1
    buffer_load_dwordx4 v[168:171], v8, s[4:7], s36 offen offset:1024 sc1
    buffer_load_dwordx4 v[172:175], v8, s[4:7], s37 offen offset:1024 sc1
    buffer_load_dwordx4 v[240:243], v8, s[4:7], s36 offen offset:2048 sc1
    buffer_load_dwordx4 v[244:247], v8, s[4:7], s37 offen offset:2048 sc1
    buffer_load_dwordx4 v[248:251], v8, s[4:7], s36 offen offset:3072 sc1
    buffer_load_dwordx4 v[252:255], v8, s[4:7], s37 offen offset:3072 sc1
    s_add_u32 s36, s36, 4096
    s_add_u32 s37, s37, 4096
    s_lshl_b32 s26, s17, 6
    s_lshl_b32 s27, s16, 6
    v_and_b32 v4, 7, v0
    v_lshrrev_b32 v5, 3, v0
    v_lshlrev_b32 v6, 15, v4
    v_lshl_add_u32 v6, v5, 1, v6
    s_lshl_b32 s28, s26, 12
    s_lshl_b32 s29, s27, 1
    s_add_u32 s28, s28, s29
    s_add_u32 s28, s28, 0x10000
    v_lshlrev_b32 v7, 5, v4
    s_lshl_b32 s29, s26, 2
    s_add_u32 s29, s29, 10240
    v_lshlrev_b32 v3, 4, v4
    s_lshl_b32 s31, s26, 1
    s_waitcnt vmcnt(14)
    v_mfma_f32_32x32x16_bf16 v[176:191], v[48:51], v[16:19], 0
    v_mfma_f32_32x32x16_bf16 v[192:207], v[48:51], v[20:23], 0
    v_mfma_f32_32x32x16_bf16 v[208:223], v[52:55], v[16:19], 0
    v_mfma_f32_32x32x16_bf16 v[224:239], v[52:55], v[20:23], 0
    buffer_load_dwordx4 v[16:19], v8, s[4:7], s36 offen offset:0 sc1
    buffer_load_dwordx4 v[20:23], v8, s[4:7], s37 offen offset:0 sc1
    s_waitcnt vmcnt(14)
    v_mfma_f32_32x32x16_bf16 v[176:191], v[56:59], v[24:27], v[176:191]
    v_mfma_f32_32x32x16_bf16 v[192:207], v[56:59], v[28:31], v[192:207]
    v_mfma_f32_32x32x16_bf16 v[208:223], v[60:63], v[24:27], v[208:223]
    v_mfma_f32_32x32x16_bf16 v[224:239], v[60:63], v[28:31], v[224:239]
    buffer_load_dwordx4 v[24:27], v8, s[4:7], s36 offen offset:1024 sc1
    buffer_load_dwordx4 v[28:31], v8, s[4:7], s37 offen offset:1024 sc1
    s_waitcnt vmcnt(14)
    v_mfma_f32_32x32x16_bf16 v[176:191], v[64:67], v[32:35], v[176:191]
    v_mfma_f32_32x32x16_bf16 v[192:207], v[64:67], v[36:39], v[192:207]
    v_mfma_f32_32x32x16_bf16 v[208:223], v[68:71], v[32:35], v[208:223]
    v_mfma_f32_32x32x16_bf16 v[224:239], v[68:71], v[36:39], v[224:239]
    buffer_load_dwordx4 v[32:35], v8, s[4:7], s36 offen offset:2048 sc1
    buffer_load_dwordx4 v[36:39], v8, s[4:7], s37 offen offset:2048 sc1
    s_waitcnt vmcnt(14)
    v_mfma_f32_32x32x16_bf16 v[176:191], v[72:75], v[40:43], v[176:191]
    v_mfma_f32_32x32x16_bf16 v[192:207], v[72:75], v[44:47], v[192:207]
    v_mfma_f32_32x32x16_bf16 v[208:223], v[76:79], v[40:43], v[208:223]
    v_mfma_f32_32x32x16_bf16 v[224:239], v[76:79], v[44:47], v[224:239]
    buffer_load_dwordx4 v[40:43], v8, s[4:7], s36 offen offset:3072 sc1
    buffer_load_dwordx4 v[44:47], v8, s[4:7], s37 offen offset:3072 sc1
    s_add_u32 s36, s36, 4096
    s_add_u32 s37, s37, 4096
    s_waitcnt vmcnt(14)
    v_mfma_f32_32x32x16_bf16 v[176:191], v[80:83], v[160:163], v[176:191]
    v_mfma_f32_32x32x16_bf16 v[192:207], v[80:83], v[164:167], v[192:207]
    v_mfma_f32_32x32x16_bf16 v[208:223], v[84:87], v[160:163], v[208:223]
    v_mfma_f32_32x32x16_bf16 v[224:239], v[84:87], v[164:167], v[224:239]
    buffer_load_dwordx4 v[160:163], v8, s[4:7], s36 offen offset:0 sc1
    buffer_load_dwordx4 v[164:167], v8, s[4:7], s37 offen offset:0 sc1
    s_waitcnt vmcnt(14)
    v_mfma_f32_32x32x16_bf16 v[176:191], v[88:91], v[168:171], v[176:191]
    v_mfma_f32_32x32x16_bf16 v[192:207], v[88:91], v[172:175], v[192:207]
    v_mfma_f32_32x32x16_bf16 v[208:223], v[92:95], v[168:171], v[208:223]
    v_mfma_f32_32x32x16_bf16 v[224:239], v[92:95], v[172:175], v[224:239]
    buffer_load_dwordx4 v[168:171], v8, s[4:7], s36 offen offset:1024 sc1
    buffer_load_dwordx4 v[172:175], v8, s[4:7], s37 offen offset:1024 sc1
    s_waitcnt vmcnt(14)
    v_mfma_f32_32x32x16_bf16 v[176:191], v[96:99], v[240:243], v[176:191]
    v_mfma_f32_32x32x16_bf16 v[192:207], v[96:99], v[244:247], v[192:207]
    v_mfma_f32_32x32x16_bf16 v[208:223], v[100:103], v[240:243], v[208:223]
    v_mfma_f32_32x32x16_bf16 v[224:239], v[100:103], v[244:247], v[224:239]
    buffer_load_ushort v48, v6, s[4:7], s28 offen
    s_add_u32 s28, s28, 4096
    buffer_load_ushort v49, v6, s[4:7], s28 offen
    s_add_u32 s28, s28, 4096
    buffer_load_ushort v50, v6, s[4:7], s28 offen
    s_add_u32 s28, s28, 4096
    buffer_load_ushort v51, v6, s[4:7], s28 offen
    s_add_u32 s28, s28, 4096
    buffer_load_ushort v52, v6, s[4:7], s28 offen
    s_add_u32 s28, s28, 4096
    buffer_load_ushort v53, v6, s[4:7], s28 offen
    s_add_u32 s28, s28, 4096
    buffer_load_ushort v54, v6, s[4:7], s28 offen
    s_add_u32 s28, s28, 4096
    buffer_load_ushort v55, v6, s[4:7], s28 offen
    s_add_u32 s28, s28, 4096
    buffer_load_dwordx4 v[56:59], v7, s[4:7], s29 offen offset:0
    buffer_load_dwordx4 v[60:63], v7, s[4:7], s29 offen offset:16
    buffer_load_dwordx4 v[64:67], v3, s[12:15], s31 offen
    s_waitcnt vmcnt(23)
    v_mfma_f32_32x32x16_bf16 v[176:191], v[104:107], v[248:251], v[176:191]
    v_mfma_f32_32x32x16_bf16 v[192:207], v[104:107], v[252:255], v[192:207]
    v_mfma_f32_32x32x16_bf16 v[208:223], v[108:111], v[248:251], v[208:223]
    v_mfma_f32_32x32x16_bf16 v[224:239], v[108:111], v[252:255], v[224:239]
    s_waitcnt vmcnt(21)
    v_mfma_f32_32x32x16_bf16 v[176:191], v[112:115], v[16:19], v[176:191]
    v_mfma_f32_32x32x16_bf16 v[192:207], v[112:115], v[20:23], v[192:207]
    v_mfma_f32_32x32x16_bf16 v[208:223], v[116:119], v[16:19], v[208:223]
    v_mfma_f32_32x32x16_bf16 v[224:239], v[116:119], v[20:23], v[224:239]
    s_waitcnt vmcnt(19)
    v_mfma_f32_32x32x16_bf16 v[176:191], v[120:123], v[24:27], v[176:191]
    v_mfma_f32_32x32x16_bf16 v[192:207], v[120:123], v[28:31], v[192:207]
    v_mfma_f32_32x32x16_bf16 v[208:223], v[124:127], v[24:27], v[208:223]
    v_mfma_f32_32x32x16_bf16 v[224:239], v[124:127], v[28:31], v[224:239]
    s_waitcnt vmcnt(17)
    v_mfma_f32_32x32x16_bf16 v[176:191], v[128:131], v[32:35], v[176:191]
    v_mfma_f32_32x32x16_bf16 v[192:207], v[128:131], v[36:39], v[192:207]
    v_mfma_f32_32x32x16_bf16 v[208:223], v[132:135], v[32:35], v[208:223]
    v_mfma_f32_32x32x16_bf16 v[224:239], v[132:135], v[36:39], v[224:239]
    s_waitcnt vmcnt(15)
    v_mfma_f32_32x32x16_bf16 v[176:191], v[136:139], v[40:43], v[176:191]
    v_mfma_f32_32x32x16_bf16 v[192:207], v[136:139], v[44:47], v[192:207]
    v_mfma_f32_32x32x16_bf16 v[208:223], v[140:143], v[40:43], v[208:223]
    v_mfma_f32_32x32x16_bf16 v[224:239], v[140:143], v[44:47], v[224:239]
    s_waitcnt vmcnt(13)
    v_mfma_f32_32x32x16_bf16 v[176:191], v[144:147], v[160:163], v[176:191]
    v_mfma_f32_32x32x16_bf16 v[192:207], v[144:147], v[164:167], v[192:207]
    v_mfma_f32_32x32x16_bf16 v[208:223], v[148:151], v[160:163], v[208:223]
    v_mfma_f32_32x32x16_bf16 v[224:239], v[148:151], v[164:167], v[224:239]
    s_waitcnt vmcnt(11)
    v_mfma_f32_32x32x16_bf16 v[176:191], v[152:155], v[168:171], v[176:191]
    v_mfma_f32_32x32x16_bf16 v[192:207], v[152:155], v[172:175], v[192:207]
    v_mfma_f32_32x32x16_bf16 v[208:223], v[156:159], v[168:171], v[208:223]
    v_mfma_f32_32x32x16_bf16 v[224:239], v[156:159], v[172:175], v[224:239]
    v_mul_u32_u24 v1, 16896, v1
    v_add_u32 v1, v1, v8
    s_nop 7
    s_nop 3
    ds_write_b128 v1, v[176:179] offset:0
    ds_write_b128 v1, v[180:183] offset:1056
    ds_write_b128 v1, v[184:187] offset:2112
    ds_write_b128 v1, v[188:191] offset:3168
    ds_write_b128 v1, v[192:195] offset:8448
    ds_write_b128 v1, v[196:199] offset:9504
    ds_write_b128 v1, v[200:203] offset:10560
    ds_write_b128 v1, v[204:207] offset:11616
    ds_write_b128 v1, v[208:211] offset:4224
    ds_write_b128 v1, v[212:215] offset:5280
    ds_write_b128 v1, v[216:219] offset:6336
    ds_write_b128 v1, v[220:223] offset:7392
    ds_write_b128 v1, v[224:227] offset:12672
    ds_write_b128 v1, v[228:231] offset:13728
    ds_write_b128 v1, v[232:235] offset:14784
    ds_write_b128 v1, v[236:239] offset:15840
    v_lshrrev_b32 v1, 5, v5
    v_mul_u32_u24 v1, 8448, v1
    v_mul_u32_u24 v9, 1056, v4
    v_add_u32 v1, v1, v9
    v_and_b32 v9, 31, v5
    v_lshl_add_u32 v1, v9, 4, v1
    v_add_u32 v9, 50688, v1
    v_add_u32 v10, 101376, v1
    s_waitcnt lgkmcnt(0)
    s_barrier
    ds_read_b128 v[80:83], v1 offset:0
    ds_read_b128 v[84:87], v1 offset:512
    ds_read_b128 v[88:91], v1 offset:16896
    ds_read_b128 v[92:95], v1 offset:17408
    ds_read_b128 v[96:99], v1 offset:33792
    ds_read_b128 v[100:103], v1 offset:34304
    ds_read_b128 v[104:107], v9 offset:0
    ds_read_b128 v[108:111], v9 offset:512
    ds_read_b128 v[112:115], v9 offset:16896
    ds_read_b128 v[116:119], v9 offset:17408
    ds_read_b128 v[120:123], v9 offset:33792
    ds_read_b128 v[124:127], v9 offset:34304
    ds_read_b128 v[128:131], v10 offset:0
    ds_read_b128 v[132:135], v10 offset:512
    ds_read_b128 v[136:139], v10 offset:16896
    ds_read_b128 v[140:143], v10 offset:17408
    v_lshlrev_b32 v6, 10, v5
    v_lshl_add_u32 v6, v4, 4, v6
    s_lshl_b32 s28, s27, 10
    s_lshl_b32 s29, s26, 1
    s_add_u32 s28, s28, s29
    s_waitcnt vmcnt(0)
    v_lshlrev_b32 v48, 16, v48
    v_lshlrev_b32 v49, 16, v49
    v_lshlrev_b32 v50, 16, v50
    v_lshlrev_b32 v51, 16, v51
    v_lshlrev_b32 v52, 16, v52
    v_lshlrev_b32 v53, 16, v53
    v_lshlrev_b32 v54, 16, v54
    v_lshlrev_b32 v55, 16, v55
    v_lshlrev_b32 v68, 16, v64
    v_and_b32 v69, 0xffff0000, v64
    v_lshlrev_b32 v70, 16, v65
    v_and_b32 v71, 0xffff0000, v65
    v_lshlrev_b32 v72, 16, v66
    v_and_b32 v73, 0xffff0000, v66
    v_lshlrev_b32 v74, 16, v67
    v_and_b32 v75, 0xffff0000, v67
    s_waitcnt lgkmcnt(0)
    v_add_f32 v80, v80, v112
    v_add_f32 v81, v81, v113
    v_add_f32 v82, v82, v114
    v_add_f32 v83, v83, v115
    v_add_f32 v84, v84, v116
    v_add_f32 v85, v85, v117
    v_add_f32 v86, v86, v118
    v_add_f32 v87, v87, v119
    v_add_f32 v88, v88, v120
    v_add_f32 v89, v89, v121
    v_add_f32 v90, v90, v122
    v_add_f32 v91, v91, v123
    v_add_f32 v92, v92, v124
    v_add_f32 v93, v93, v125
    v_add_f32 v94, v94, v126
    v_add_f32 v95, v95, v127
    v_add_f32 v96, v96, v128
    v_add_f32 v97, v97, v129
    v_add_f32 v98, v98, v130
    v_add_f32 v99, v99, v131
    v_add_f32 v100, v100, v132
    v_add_f32 v101, v101, v133
    v_add_f32 v102, v102, v134
    v_add_f32 v103, v103, v135
    v_add_f32 v104, v104, v136
    v_add_f32 v105, v105, v137
    v_add_f32 v106, v106, v138
    v_add_f32 v107, v107, v139
    v_add_f32 v108, v108, v140
    v_add_f32 v109, v109, v141
    v_add_f32 v110, v110, v142
    v_add_f32 v111, v111, v143
    v_add_f32 v80, v80, v96
    v_add_f32 v81, v81, v97
    v_add_f32 v82, v82, v98
    v_add_f32 v83, v83, v99
    v_add_f32 v84, v84, v100
    v_add_f32 v85, v85, v101
    v_add_f32 v86, v86, v102
    v_add_f32 v87, v87, v103
    v_add_f32 v88, v88, v104
    v_add_f32 v89, v89, v105
    v_add_f32 v90, v90, v106
    v_add_f32 v91, v91, v107
    v_add_f32 v92, v92, v108
    v_add_f32 v93, v93, v109
    v_add_f32 v94, v94, v110
    v_add_f32 v95, v95, v111
    v_add_f32 v80, v80, v88
    v_add_f32 v81, v81, v89
    v_add_f32 v82, v82, v90
    v_add_f32 v83, v83, v91
    v_add_f32 v84, v84, v92
    v_add_f32 v85, v85, v93
    v_add_f32 v86, v86, v94
    v_add_f32 v87, v87, v95
    v_cvt_pk_bf16_f32 v24, v80, v81
    v_lshlrev_b32 v80, 16, v24
    v_and_b32 v81, 0xffff0000, v24
    v_cvt_pk_bf16_f32 v24, v82, v83
    v_lshlrev_b32 v82, 16, v24
    v_and_b32 v83, 0xffff0000, v24
    v_cvt_pk_bf16_f32 v24, v84, v85
    v_lshlrev_b32 v84, 16, v24
    v_and_b32 v85, 0xffff0000, v24
    v_cvt_pk_bf16_f32 v24, v86, v87
    v_lshlrev_b32 v86, 16, v24
    v_and_b32 v87, 0xffff0000, v24
    v_add_f32 v80, v80, v68
    v_add_f32 v81, v81, v69
    v_add_f32 v82, v82, v70
    v_add_f32 v83, v83, v71
    v_add_f32 v84, v84, v72
    v_add_f32 v85, v85, v73
    v_add_f32 v86, v86, v74
    v_add_f32 v87, v87, v75
    v_cvt_pk_bf16_f32 v24, v80, v81
    v_lshlrev_b32 v80, 16, v24
    v_and_b32 v81, 0xffff0000, v24
    v_cvt_pk_bf16_f32 v24, v82, v83
    v_lshlrev_b32 v82, 16, v24
    v_and_b32 v83, 0xffff0000, v24
    v_cvt_pk_bf16_f32 v24, v84, v85
    v_lshlrev_b32 v84, 16, v24
    v_and_b32 v85, 0xffff0000, v24
    v_cvt_pk_bf16_f32 v24, v86, v87
    v_lshlrev_b32 v86, 16, v24
    v_and_b32 v87, 0xffff0000, v24
    v_mul_f32 v80, v80, v56
    v_mul_f32 v81, v81, v57
    v_mul_f32 v82, v82, v58
    v_mul_f32 v83, v83, v59
    v_mul_f32 v84, v84, v60
    v_mul_f32 v85, v85, v61
    v_mul_f32 v86, v86, v62
    v_mul_f32 v87, v87, v63
    v_cvt_pk_bf16_f32 v24, v80, v81
    v_lshlrev_b32 v80, 16, v24
    v_and_b32 v81, 0xffff0000, v24
    v_cvt_pk_bf16_f32 v24, v82, v83
    v_lshlrev_b32 v82, 16, v24
    v_and_b32 v83, 0xffff0000, v24
    v_cvt_pk_bf16_f32 v24, v84, v85
    v_lshlrev_b32 v84, 16, v24
    v_and_b32 v85, 0xffff0000, v24
    v_cvt_pk_bf16_f32 v24, v86, v87
    v_lshlrev_b32 v86, 16, v24
    v_and_b32 v87, 0xffff0000, v24
    v_add_f32 v80, v80, v48
    v_add_f32 v81, v81, v49
    v_add_f32 v82, v82, v50
    v_add_f32 v83, v83, v51
    v_add_f32 v84, v84, v52
    v_add_f32 v85, v85, v53
    v_add_f32 v86, v86, v54
    v_add_f32 v87, v87, v55
    v_cvt_pk_bf16_f32 v24, v80, v81
    v_cvt_pk_bf16_f32 v25, v82, v83
    v_cvt_pk_bf16_f32 v26, v84, v85
    v_cvt_pk_bf16_f32 v27, v86, v87
    buffer_store_dwordx4 v[24:27], v6, s[8:11], s28 offen
F_END:
    s_endpgm
F_ST:
    s_setprio 2
    buffer_load_dwordx4 v[176:179], v5, s[4:7], s19 offen
    s_add_u32 s19, s19, 0x40000
    buffer_load_dwordx4 v[180:183], v5, s[4:7], s19 offen
    s_add_u32 s19, s19, 0x40000
    buffer_load_dwordx4 v[184:187], v5, s[4:7], s19 offen
    s_add_u32 s19, s19, 0x40000
    buffer_load_dwordx4 v[188:191], v5, s[4:7], s19 offen
    s_add_u32 s19, s19, 0x40000
    buffer_load_dwordx4 v[192:195], v5, s[4:7], s19 offen
    s_add_u32 s19, s19, 0x40000
    buffer_load_dwordx4 v[196:199], v5, s[4:7], s19 offen
    s_add_u32 s19, s19, 0x40000
    buffer_load_dwordx4 v[200:203], v5, s[4:7], s19 offen
    s_add_u32 s19, s19, 0x40000
    buffer_load_dwordx4 v[204:207], v5, s[4:7], s19 offen
    s_add_u32 s19, s19, 0x40000
    buffer_load_dwordx4 v[48:51], v8, s[4:7], s34 offen offset:0
    buffer_load_dwordx4 v[52:55], v8, s[4:7], s35 offen offset:0
    buffer_load_dwordx4 v[56:59], v8, s[4:7], s34 offen offset:1024
    buffer_load_dwordx4 v[60:63], v8, s[4:7], s35 offen offset:1024
    buffer_load_dwordx4 v[64:67], v8, s[4:7], s34 offen offset:2048
    buffer_load_dwordx4 v[68:71], v8, s[4:7], s35 offen offset:2048
    buffer_load_dwordx4 v[72:75], v8, s[4:7], s34 offen offset:3072
    buffer_load_dwordx4 v[76:79], v8, s[4:7], s35 offen offset:3072
    s_add_u32 s34, s34, 4096
    s_add_u32 s35, s35, 4096
    buffer_load_dwordx4 v[80:83], v8, s[4:7], s34 offen offset:0
    buffer_load_dwordx4 v[84:87], v8, s[4:7], s35 offen offset:0
    buffer_load_dwordx4 v[88:91], v8, s[4:7], s34 offen offset:1024
    buffer_load_dwordx4 v[92:95], v8, s[4:7], s35 offen offset:1024
    buffer_load_dwordx4 v[96:99], v8, s[4:7], s34 offen offset:2048
    buffer_load_dwordx4 v[100:103], v8, s[4:7], s35 offen offset:2048
    buffer_load_dwordx4 v[104:107], v8, s[4:7], s34 offen offset:3072
    buffer_load_dwordx4 v[108:111], v8, s[4:7], s35 offen offset:3072
    s_add_u32 s34, s34, 4096
    s_add_u32 s35, s35, 4096
    buffer_load_dwordx4 v[112:115], v8, s[4:7], s34 offen offset:0
    buffer_load_dwordx4 v[116:119], v8, s[4:7], s35 offen offset:0
    buffer_load_dwordx4 v[120:123], v8, s[4:7], s34 offen offset:1024
    buffer_load_dwordx4 v[124:127], v8, s[4:7], s35 offen offset:1024
    buffer_load_dwordx4 v[128:131], v8, s[4:7], s34 offen offset:2048
    buffer_load_dwordx4 v[132:135], v8, s[4:7], s35 offen offset:2048
    buffer_load_dwordx4 v[136:139], v8, s[4:7], s34 offen offset:3072
    buffer_load_dwordx4 v[140:143], v8, s[4:7], s35 offen offset:3072
    s_add_u32 s34, s34, 4096
    s_add_u32 s35, s35, 4096
    buffer_load_dwordx4 v[144:147], v8, s[4:7], s34 offen offset:0
    buffer_load_dwordx4 v[148:151], v8, s[4:7], s35 offen offset:0
    buffer_load_dwordx4 v[152:155], v8, s[4:7], s34 offen offset:1024
    buffer_load_dwordx4 v[156:159], v8, s[4:7], s35 offen offset:1024
    v_lshrrev_b32 v10, 2, v2
    v_lshlrev_b32 v10, 6, v10
    v_and_b32 v11, 3, v2
    v_lshl_add_u32 v10, v11, 3, v10
    v_mov_b32 v12, 0x3f803f80
    v_mov_b32 v13, 0x3f803f80
    v_mov_b32 v14, 0x3f803f80
    v_mov_b32 v15, 0x3f803f80
    s_waitcnt vmcnt(35)
    ds_write_b128 v6, v[176:179] offset:0
    s_waitcnt vmcnt(34)
    ds_write_b128 v6, v[180:183] offset:4096
    s_waitcnt lgkmcnt(0)
    s_barrier
    ds_read_b64_tr_b16 v[160:161], v10 offset:0
    ds_read_b64_tr_b16 v[162:163], v10 offset:1024
    ds_read_b64_tr_b16 v[164:165], v10 offset:32
    ds_read_b64_tr_b16 v[166:167], v10 offset:1056
    ds_read_b64_tr_b16 v[168:169], v10 offset:32768
    ds_read_b64_tr_b16 v[170:171], v10 offset:33792
    ds_read_b64_tr_b16 v[172:173], v10 offset:32800
    ds_read_b64_tr_b16 v[174:175], v10 offset:33824
    ds_read_b64_tr_b16 v[208:209], v10 offset:2048
    ds_read_b64_tr_b16 v[210:211], v10 offset:3072
    ds_read_b64_tr_b16 v[212:213], v10 offset:2080
    ds_read_b64_tr_b16 v[214:215], v10 offset:3104
    ds_read_b64_tr_b16 v[216:217], v10 offset:34816
    ds_read_b64_tr_b16 v[218:219], v10 offset:35840
    ds_read_b64_tr_b16 v[220:221], v10 offset:34848
    ds_read_b64_tr_b16 v[222:223], v10 offset:35872
    s_waitcnt lgkmcnt(8)
    ds_read_b64_tr_b16 v[224:225], v10 offset:4096
    ds_read_b64_tr_b16 v[226:227], v10 offset:5120
    ds_read_b64_tr_b16 v[228:229], v10 offset:4128
    ds_read_b64_tr_b16 v[230:231], v10 offset:5152
    ds_read_b64_tr_b16 v[232:233], v10 offset:36864
    ds_read_b64_tr_b16 v[234:235], v10 offset:37888
    ds_read_b64_tr_b16 v[236:237], v10 offset:36896
    ds_read_b64_tr_b16 v[238:239], v10 offset:37920
    v_mfma_f32_16x16x32_bf16 v[16:19], v[160:163], v[160:163], 0
    v_mfma_f32_16x16x32_bf16 v[32:35], v[12:15], v[160:163], 0
    v_mfma_f32_16x16x32_bf16 v[20:23], v[164:167], v[164:167], 0
    v_mfma_f32_16x16x32_bf16 v[36:39], v[12:15], v[164:167], 0
    v_mfma_f32_16x16x32_bf16 v[24:27], v[168:171], v[168:171], 0
    v_mfma_f32_16x16x32_bf16 v[40:43], v[12:15], v[168:171], 0
    v_mfma_f32_16x16x32_bf16 v[28:31], v[172:175], v[172:175], 0
    v_mfma_f32_16x16x32_bf16 v[44:47], v[12:15], v[172:175], 0
    s_waitcnt lgkmcnt(8)
    ds_read_b64_tr_b16 v[160:161], v10 offset:6144
    ds_read_b64_tr_b16 v[162:163], v10 offset:7168
    ds_read_b64_tr_b16 v[164:165], v10 offset:6176
    ds_read_b64_tr_b16 v[166:167], v10 offset:7200
    ds_read_b64_tr_b16 v[168:169], v10 offset:38912
    ds_read_b64_tr_b16 v[170:171], v10 offset:39936
    ds_read_b64_tr_b16 v[172:173], v10 offset:38944
    ds_read_b64_tr_b16 v[174:175], v10 offset:39968
    v_mfma_f32_16x16x32_bf16 v[16:19], v[208:211], v[208:211], v[16:19]
    v_mfma_f32_16x16x32_bf16 v[32:35], v[12:15], v[208:211], v[32:35]
    v_mfma_f32_16x16x32_bf16 v[20:23], v[212:215], v[212:215], v[20:23]
    v_mfma_f32_16x16x32_bf16 v[36:39], v[12:15], v[212:215], v[36:39]
    v_mfma_f32_16x16x32_bf16 v[24:27], v[216:219], v[216:219], v[24:27]
    v_mfma_f32_16x16x32_bf16 v[40:43], v[12:15], v[216:219], v[40:43]
    v_mfma_f32_16x16x32_bf16 v[28:31], v[220:223], v[220:223], v[28:31]
    v_mfma_f32_16x16x32_bf16 v[44:47], v[12:15], v[220:223], v[44:47]
    s_waitcnt lgkmcnt(8)
    v_mfma_f32_16x16x32_bf16 v[16:19], v[224:227], v[224:227], v[16:19]
    v_mfma_f32_16x16x32_bf16 v[32:35], v[12:15], v[224:227], v[32:35]
    v_mfma_f32_16x16x32_bf16 v[20:23], v[228:231], v[228:231], v[20:23]
    v_mfma_f32_16x16x32_bf16 v[36:39], v[12:15], v[228:231], v[36:39]
    v_mfma_f32_16x16x32_bf16 v[24:27], v[232:235], v[232:235], v[24:27]
    v_mfma_f32_16x16x32_bf16 v[40:43], v[12:15], v[232:235], v[40:43]
    v_mfma_f32_16x16x32_bf16 v[28:31], v[236:239], v[236:239], v[28:31]
    v_mfma_f32_16x16x32_bf16 v[44:47], v[12:15], v[236:239], v[44:47]
    s_waitcnt vmcnt(33)
    ds_write_b128 v6, v[184:187] offset:8192
    s_waitcnt vmcnt(32)
    ds_write_b128 v6, v[188:191] offset:12288
    s_waitcnt lgkmcnt(2)
    v_mfma_f32_16x16x32_bf16 v[16:19], v[160:163], v[160:163], v[16:19]
    v_mfma_f32_16x16x32_bf16 v[32:35], v[12:15], v[160:163], v[32:35]
    v_mfma_f32_16x16x32_bf16 v[20:23], v[164:167], v[164:167], v[20:23]
    v_mfma_f32_16x16x32_bf16 v[36:39], v[12:15], v[164:167], v[36:39]
    v_mfma_f32_16x16x32_bf16 v[24:27], v[168:171], v[168:171], v[24:27]
    v_mfma_f32_16x16x32_bf16 v[40:43], v[12:15], v[168:171], v[40:43]
    v_mfma_f32_16x16x32_bf16 v[28:31], v[172:175], v[172:175], v[28:31]
    v_mfma_f32_16x16x32_bf16 v[44:47], v[12:15], v[172:175], v[44:47]
    s_waitcnt lgkmcnt(0)
    s_barrier
    ds_read_b64_tr_b16 v[208:209], v10 offset:8192
    ds_read_b64_tr_b16 v[210:211], v10 offset:9216
    ds_read_b64_tr_b16 v[212:213], v10 offset:8224
    ds_read_b64_tr_b16 v[214:215], v10 offset:9248
    ds_read_b64_tr_b16 v[216:217], v10 offset:40960
    ds_read_b64_tr_b16 v[218:219], v10 offset:41984
    ds_read_b64_tr_b16 v[220:221], v10 offset:40992
    ds_read_b64_tr_b16 v[222:223], v10 offset:42016
    ds_read_b64_tr_b16 v[224:225], v10 offset:10240
    ds_read_b64_tr_b16 v[226:227], v10 offset:11264
    ds_read_b64_tr_b16 v[228:229], v10 offset:10272
    ds_read_b64_tr_b16 v[230:231], v10 offset:11296
    ds_read_b64_tr_b16 v[232:233], v10 offset:43008
    ds_read_b64_tr_b16 v[234:235], v10 offset:44032
    ds_read_b64_tr_b16 v[236:237], v10 offset:43040
    ds_read_b64_tr_b16 v[238:239], v10 offset:44064
    s_waitcnt lgkmcnt(8)
    ds_read_b64_tr_b16 v[160:161], v10 offset:12288
    ds_read_b64_tr_b16 v[162:163], v10 offset:13312
    ds_read_b64_tr_b16 v[164:165], v10 offset:12320
    ds_read_b64_tr_b16 v[166:167], v10 offset:13344
    ds_read_b64_tr_b16 v[168:169], v10 offset:45056
    ds_read_b64_tr_b16 v[170:171], v10 offset:46080
    ds_read_b64_tr_b16 v[172:173], v10 offset:45088
    ds_read_b64_tr_b16 v[174:175], v10 offset:46112
    v_mfma_f32_16x16x32_bf16 v[16:19], v[208:211], v[208:211], v[16:19]
    v_mfma_f32_16x16x32_bf16 v[32:35], v[12:15], v[208:211], v[32:35]
    v_mfma_f32_16x16x32_bf16 v[20:23], v[212:215], v[212:215], v[20:23]
    v_mfma_f32_16x16x32_bf16 v[36:39], v[12:15], v[212:215], v[36:39]
    v_mfma_f32_16x16x32_bf16 v[24:27], v[216:219], v[216:219], v[24:27]
    v_mfma_f32_16x16x32_bf16 v[40:43], v[12:15], v[216:219], v[40:43]
    v_mfma_f32_16x16x32_bf16 v[28:31], v[220:223], v[220:223], v[28:31]
    v_mfma_f32_16x16x32_bf16 v[44:47], v[12:15], v[220:223], v[44:47]
    s_waitcnt lgkmcnt(8)
    ds_read_b64_tr_b16 v[208:209], v10 offset:14336
    ds_read_b64_tr_b16 v[210:211], v10 offset:15360
    ds_read_b64_tr_b16 v[212:213], v10 offset:14368
    ds_read_b64_tr_b16 v[214:215], v10 offset:15392
    ds_read_b64_tr_b16 v[216:217], v10 offset:47104
    ds_read_b64_tr_b16 v[218:219], v10 offset:48128
    ds_read_b64_tr_b16 v[220:221], v10 offset:47136
    ds_read_b64_tr_b16 v[222:223], v10 offset:48160
    v_mfma_f32_16x16x32_bf16 v[16:19], v[224:227], v[224:227], v[16:19]
    v_mfma_f32_16x16x32_bf16 v[32:35], v[12:15], v[224:227], v[32:35]
    v_mfma_f32_16x16x32_bf16 v[20:23], v[228:231], v[228:231], v[20:23]
    v_mfma_f32_16x16x32_bf16 v[36:39], v[12:15], v[228:231], v[36:39]
    v_mfma_f32_16x16x32_bf16 v[24:27], v[232:235], v[232:235], v[24:27]
    v_mfma_f32_16x16x32_bf16 v[40:43], v[12:15], v[232:235], v[40:43]
    v_mfma_f32_16x16x32_bf16 v[28:31], v[236:239], v[236:239], v[28:31]
    v_mfma_f32_16x16x32_bf16 v[44:47], v[12:15], v[236:239], v[44:47]
    s_waitcnt lgkmcnt(8)
    v_mfma_f32_16x16x32_bf16 v[16:19], v[160:163], v[160:163], v[16:19]
    v_mfma_f32_16x16x32_bf16 v[32:35], v[12:15], v[160:163], v[32:35]
    v_mfma_f32_16x16x32_bf16 v[20:23], v[164:167], v[164:167], v[20:23]
    v_mfma_f32_16x16x32_bf16 v[36:39], v[12:15], v[164:167], v[36:39]
    v_mfma_f32_16x16x32_bf16 v[24:27], v[168:171], v[168:171], v[24:27]
    v_mfma_f32_16x16x32_bf16 v[40:43], v[12:15], v[168:171], v[40:43]
    v_mfma_f32_16x16x32_bf16 v[28:31], v[172:175], v[172:175], v[28:31]
    v_mfma_f32_16x16x32_bf16 v[44:47], v[12:15], v[172:175], v[44:47]
    s_waitcnt vmcnt(31)
    ds_write_b128 v6, v[192:195] offset:16384
    s_waitcnt vmcnt(30)
    ds_write_b128 v6, v[196:199] offset:20480
    s_waitcnt lgkmcnt(2)
    v_mfma_f32_16x16x32_bf16 v[16:19], v[208:211], v[208:211], v[16:19]
    v_mfma_f32_16x16x32_bf16 v[32:35], v[12:15], v[208:211], v[32:35]
    v_mfma_f32_16x16x32_bf16 v[20:23], v[212:215], v[212:215], v[20:23]
    v_mfma_f32_16x16x32_bf16 v[36:39], v[12:15], v[212:215], v[36:39]
    v_mfma_f32_16x16x32_bf16 v[24:27], v[216:219], v[216:219], v[24:27]
    v_mfma_f32_16x16x32_bf16 v[40:43], v[12:15], v[216:219], v[40:43]
    v_mfma_f32_16x16x32_bf16 v[28:31], v[220:223], v[220:223], v[28:31]
    v_mfma_f32_16x16x32_bf16 v[44:47], v[12:15], v[220:223], v[44:47]
    s_waitcnt lgkmcnt(0)
    s_barrier
    ds_read_b64_tr_b16 v[224:225], v10 offset:16384
    ds_read_b64_tr_b16 v[226:227], v10 offset:17408
    ds_read_b64_tr_b16 v[228:229], v10 offset:16416
    ds_read_b64_tr_b16 v[230:231], v10 offset:17440
    ds_read_b64_tr_b16 v[232:233], v10 offset:49152
    ds_read_b64_tr_b16 v[234:235], v10 offset:50176
    ds_read_b64_tr_b16 v[236:237], v10 offset:49184
    ds_read_b64_tr_b16 v[238:239], v10 offset:50208
    ds_read_b64_tr_b16 v[160:161], v10 offset:18432
    ds_read_b64_tr_b16 v[162:163], v10 offset:19456
    ds_read_b64_tr_b16 v[164:165], v10 offset:18464
    ds_read_b64_tr_b16 v[166:167], v10 offset:19488
    ds_read_b64_tr_b16 v[168:169], v10 offset:51200
    ds_read_b64_tr_b16 v[170:171], v10 offset:52224
    ds_read_b64_tr_b16 v[172:173], v10 offset:51232
    ds_read_b64_tr_b16 v[174:175], v10 offset:52256
    s_waitcnt lgkmcnt(8)
    ds_read_b64_tr_b16 v[208:209], v10 offset:20480
    ds_read_b64_tr_b16 v[210:211], v10 offset:21504
    ds_read_b64_tr_b16 v[212:213], v10 offset:20512
    ds_read_b64_tr_b16 v[214:215], v10 offset:21536
    ds_read_b64_tr_b16 v[216:217], v10 offset:53248
    ds_read_b64_tr_b16 v[218:219], v10 offset:54272
    ds_read_b64_tr_b16 v[220:221], v10 offset:53280
    ds_read_b64_tr_b16 v[222:223], v10 offset:54304
    v_mfma_f32_16x16x32_bf16 v[16:19], v[224:227], v[224:227], v[16:19]
    v_mfma_f32_16x16x32_bf16 v[32:35], v[12:15], v[224:227], v[32:35]
    v_mfma_f32_16x16x32_bf16 v[20:23], v[228:231], v[228:231], v[20:23]
    v_mfma_f32_16x16x32_bf16 v[36:39], v[12:15], v[228:231], v[36:39]
    v_mfma_f32_16x16x32_bf16 v[24:27], v[232:235], v[232:235], v[24:27]
    v_mfma_f32_16x16x32_bf16 v[40:43], v[12:15], v[232:235], v[40:43]
    v_mfma_f32_16x16x32_bf16 v[28:31], v[236:239], v[236:239], v[28:31]
    v_mfma_f32_16x16x32_bf16 v[44:47], v[12:15], v[236:239], v[44:47]
    s_waitcnt lgkmcnt(8)
    ds_read_b64_tr_b16 v[224:225], v10 offset:22528
    ds_read_b64_tr_b16 v[226:227], v10 offset:23552
    ds_read_b64_tr_b16 v[228:229], v10 offset:22560
    ds_read_b64_tr_b16 v[230:231], v10 offset:23584
    ds_read_b64_tr_b16 v[232:233], v10 offset:55296
    ds_read_b64_tr_b16 v[234:235], v10 offset:56320
    ds_read_b64_tr_b16 v[236:237], v10 offset:55328
    ds_read_b64_tr_b16 v[238:239], v10 offset:56352
    v_mfma_f32_16x16x32_bf16 v[16:19], v[160:163], v[160:163], v[16:19]
    v_mfma_f32_16x16x32_bf16 v[32:35], v[12:15], v[160:163], v[32:35]
    v_mfma_f32_16x16x32_bf16 v[20:23], v[164:167], v[164:167], v[20:23]
    v_mfma_f32_16x16x32_bf16 v[36:39], v[12:15], v[164:167], v[36:39]
    v_mfma_f32_16x16x32_bf16 v[24:27], v[168:171], v[168:171], v[24:27]
    v_mfma_f32_16x16x32_bf16 v[40:43], v[12:15], v[168:171], v[40:43]
    v_mfma_f32_16x16x32_bf16 v[28:31], v[172:175], v[172:175], v[28:31]
    v_mfma_f32_16x16x32_bf16 v[44:47], v[12:15], v[172:175], v[44:47]
    s_waitcnt lgkmcnt(8)
    v_mfma_f32_16x16x32_bf16 v[16:19], v[208:211], v[208:211], v[16:19]
    v_mfma_f32_16x16x32_bf16 v[32:35], v[12:15], v[208:211], v[32:35]
    v_mfma_f32_16x16x32_bf16 v[20:23], v[212:215], v[212:215], v[20:23]
    v_mfma_f32_16x16x32_bf16 v[36:39], v[12:15], v[212:215], v[36:39]
    v_mfma_f32_16x16x32_bf16 v[24:27], v[216:219], v[216:219], v[24:27]
    v_mfma_f32_16x16x32_bf16 v[40:43], v[12:15], v[216:219], v[40:43]
    v_mfma_f32_16x16x32_bf16 v[28:31], v[220:223], v[220:223], v[28:31]
    v_mfma_f32_16x16x32_bf16 v[44:47], v[12:15], v[220:223], v[44:47]
    s_waitcnt vmcnt(29)
    ds_write_b128 v6, v[200:203] offset:24576
    s_waitcnt vmcnt(28)
    ds_write_b128 v6, v[204:207] offset:28672
    s_waitcnt lgkmcnt(2)
    v_mfma_f32_16x16x32_bf16 v[16:19], v[224:227], v[224:227], v[16:19]
    v_mfma_f32_16x16x32_bf16 v[32:35], v[12:15], v[224:227], v[32:35]
    v_mfma_f32_16x16x32_bf16 v[20:23], v[228:231], v[228:231], v[20:23]
    v_mfma_f32_16x16x32_bf16 v[36:39], v[12:15], v[228:231], v[36:39]
    v_mfma_f32_16x16x32_bf16 v[24:27], v[232:235], v[232:235], v[24:27]
    v_mfma_f32_16x16x32_bf16 v[40:43], v[12:15], v[232:235], v[40:43]
    v_mfma_f32_16x16x32_bf16 v[28:31], v[236:239], v[236:239], v[28:31]
    v_mfma_f32_16x16x32_bf16 v[44:47], v[12:15], v[236:239], v[44:47]
    s_waitcnt lgkmcnt(0)
    s_barrier
    ds_read_b64_tr_b16 v[160:161], v10 offset:24576
    ds_read_b64_tr_b16 v[162:163], v10 offset:25600
    ds_read_b64_tr_b16 v[164:165], v10 offset:24608
    ds_read_b64_tr_b16 v[166:167], v10 offset:25632
    ds_read_b64_tr_b16 v[168:169], v10 offset:57344
    ds_read_b64_tr_b16 v[170:171], v10 offset:58368
    ds_read_b64_tr_b16 v[172:173], v10 offset:57376
    ds_read_b64_tr_b16 v[174:175], v10 offset:58400
    ds_read_b64_tr_b16 v[208:209], v10 offset:26624
    ds_read_b64_tr_b16 v[210:211], v10 offset:27648
    ds_read_b64_tr_b16 v[212:213], v10 offset:26656
    ds_read_b64_tr_b16 v[214:215], v10 offset:27680
    ds_read_b64_tr_b16 v[216:217], v10 offset:59392
    ds_read_b64_tr_b16 v[218:219], v10 offset:60416
    ds_read_b64_tr_b16 v[220:221], v10 offset:59424
    ds_read_b64_tr_b16 v[222:223], v10 offset:60448
    s_waitcnt lgkmcnt(8)
    ds_read_b64_tr_b16 v[224:225], v10 offset:28672
    ds_read_b64_tr_b16 v[226:227], v10 offset:29696
    ds_read_b64_tr_b16 v[228:229], v10 offset:28704
    ds_read_b64_tr_b16 v[230:231], v10 offset:29728
    ds_read_b64_tr_b16 v[232:233], v10 offset:61440
    ds_read_b64_tr_b16 v[234:235], v10 offset:62464
    ds_read_b64_tr_b16 v[236:237], v10 offset:61472
    ds_read_b64_tr_b16 v[238:239], v10 offset:62496
    v_mfma_f32_16x16x32_bf16 v[16:19], v[160:163], v[160:163], v[16:19]
    v_mfma_f32_16x16x32_bf16 v[32:35], v[12:15], v[160:163], v[32:35]
    v_mfma_f32_16x16x32_bf16 v[20:23], v[164:167], v[164:167], v[20:23]
    v_mfma_f32_16x16x32_bf16 v[36:39], v[12:15], v[164:167], v[36:39]
    v_mfma_f32_16x16x32_bf16 v[24:27], v[168:171], v[168:171], v[24:27]
    v_mfma_f32_16x16x32_bf16 v[40:43], v[12:15], v[168:171], v[40:43]
    v_mfma_f32_16x16x32_bf16 v[28:31], v[172:175], v[172:175], v[28:31]
    v_mfma_f32_16x16x32_bf16 v[44:47], v[12:15], v[172:175], v[44:47]
    s_waitcnt lgkmcnt(8)
    ds_read_b64_tr_b16 v[160:161], v10 offset:30720
    ds_read_b64_tr_b16 v[162:163], v10 offset:31744
    ds_read_b64_tr_b16 v[164:165], v10 offset:30752
    ds_read_b64_tr_b16 v[166:167], v10 offset:31776
    ds_read_b64_tr_b16 v[168:169], v10 offset:63488
    ds_read_b64_tr_b16 v[170:171], v10 offset:64512
    ds_read_b64_tr_b16 v[172:173], v10 offset:63520
    ds_read_b64_tr_b16 v[174:175], v10 offset:64544
    v_mfma_f32_16x16x32_bf16 v[16:19], v[208:211], v[208:211], v[16:19]
    v_mfma_f32_16x16x32_bf16 v[32:35], v[12:15], v[208:211], v[32:35]
    v_mfma_f32_16x16x32_bf16 v[20:23], v[212:215], v[212:215], v[20:23]
    v_mfma_f32_16x16x32_bf16 v[36:39], v[12:15], v[212:215], v[36:39]
    v_mfma_f32_16x16x32_bf16 v[24:27], v[216:219], v[216:219], v[24:27]
    v_mfma_f32_16x16x32_bf16 v[40:43], v[12:15], v[216:219], v[40:43]
    v_mfma_f32_16x16x32_bf16 v[28:31], v[220:223], v[220:223], v[28:31]
    v_mfma_f32_16x16x32_bf16 v[44:47], v[12:15], v[220:223], v[44:47]
    s_waitcnt lgkmcnt(8)
    v_mfma_f32_16x16x32_bf16 v[16:19], v[224:227], v[224:227], v[16:19]
    v_mfma_f32_16x16x32_bf16 v[32:35], v[12:15], v[224:227], v[32:35]
    v_mfma_f32_16x16x32_bf16 v[20:23], v[228:231], v[228:231], v[20:23]
    v_mfma_f32_16x16x32_bf16 v[36:39], v[12:15], v[228:231], v[36:39]
    v_mfma_f32_16x16x32_bf16 v[24:27], v[232:235], v[232:235], v[24:27]
    v_mfma_f32_16x16x32_bf16 v[40:43], v[12:15], v[232:235], v[40:43]
    v_mfma_f32_16x16x32_bf16 v[28:31], v[236:239], v[236:239], v[28:31]
    v_mfma_f32_16x16x32_bf16 v[44:47], v[12:15], v[236:239], v[44:47]
    s_waitcnt lgkmcnt(0)
    v_mfma_f32_16x16x32_bf16 v[16:19], v[160:163], v[160:163], v[16:19]
    v_mfma_f32_16x16x32_bf16 v[32:35], v[12:15], v[160:163], v[32:35]
    v_mfma_f32_16x16x32_bf16 v[20:23], v[164:167], v[164:167], v[20:23]
    v_mfma_f32_16x16x32_bf16 v[36:39], v[12:15], v[164:167], v[36:39]
    v_mfma_f32_16x16x32_bf16 v[24:27], v[168:171], v[168:171], v[24:27]
    v_mfma_f32_16x16x32_bf16 v[40:43], v[12:15], v[168:171], v[40:43]
    v_mfma_f32_16x16x32_bf16 v[28:31], v[172:175], v[172:175], v[28:31]
    v_mfma_f32_16x16x32_bf16 v[44:47], v[12:15], v[172:175], v[44:47]
    v_and_b32 v11, 3, v2
    v_cmp_eq_u32 s[24:25], 1, v11
    v_cmp_eq_u32 s[26:27], 2, v11
    v_cmp_eq_u32 s[28:29], 3, v11
    v_bfe_u32 v3, v2, 2, 2
    v_lshrrev_b32 v4, 4, v2
    v_cmp_eq_u32 vcc, v3, v4
    v_and_b32 v5, 15, v2
    v_lshlrev_b32 v5, 3, v5
    v_add_u32 v5, 0x10000, v5
    s_nop 7
    v_cndmask_b32 v16, v16, v17, s[24:25]
    v_cndmask_b32 v16, v16, v18, s[26:27]
    v_cndmask_b32 v16, v16, v19, s[28:29]
    v_mul_f32 v32, 0x3b000000, v32
    v_mul_f32 v16, 0x3b000000, v16
    v_fma_f32 v16, -v32, v32, v16
    v_max_f32 v16, 0, v16
    v_cvt_pk_bf16_f32 v16, v16, v16
    v_and_b32 v16, 0xffff0000, v16
    v_cvt_pk_bf16_f32 v32, v32, v32
    v_and_b32 v32, 0xffff0000, v32
    v_add_f32 v16, 0x3727c5ac, v16
    v_cvt_pk_bf16_f32 v16, v16, v16
    v_and_b32 v16, 0xffff0000, v16
    v_sqrt_f32 v16, v16
    s_nop 0
    v_cvt_pk_bf16_f32 v16, v16, v16
    v_and_b32 v16, 0xffff0000, v16
    v_rcp_f32 v33, v16
    v_cndmask_b32 v20, v20, v21, s[24:25]
    v_cndmask_b32 v20, v20, v22, s[26:27]
    v_cndmask_b32 v20, v20, v23, s[28:29]
    v_mul_f32 v36, 0x3b000000, v36
    v_mul_f32 v20, 0x3b000000, v20
    v_fma_f32 v20, -v36, v36, v20
    v_max_f32 v20, 0, v20
    v_cvt_pk_bf16_f32 v20, v20, v20
    v_and_b32 v20, 0xffff0000, v20
    v_cvt_pk_bf16_f32 v36, v36, v36
    v_and_b32 v36, 0xffff0000, v36
    v_add_f32 v20, 0x3727c5ac, v20
    v_cvt_pk_bf16_f32 v20, v20, v20
    v_and_b32 v20, 0xffff0000, v20
    v_sqrt_f32 v20, v20
    s_nop 0
    v_cvt_pk_bf16_f32 v20, v20, v20
    v_and_b32 v20, 0xffff0000, v20
    v_rcp_f32 v37, v20
    v_cndmask_b32 v24, v24, v25, s[24:25]
    v_cndmask_b32 v24, v24, v26, s[26:27]
    v_cndmask_b32 v24, v24, v27, s[28:29]
    v_mul_f32 v40, 0x3b000000, v40
    v_mul_f32 v24, 0x3b000000, v24
    v_fma_f32 v24, -v40, v40, v24
    v_max_f32 v24, 0, v24
    v_cvt_pk_bf16_f32 v24, v24, v24
    v_and_b32 v24, 0xffff0000, v24
    v_cvt_pk_bf16_f32 v40, v40, v40
    v_and_b32 v40, 0xffff0000, v40
    v_add_f32 v24, 0x3727c5ac, v24
    v_cvt_pk_bf16_f32 v24, v24, v24
    v_and_b32 v24, 0xffff0000, v24
    v_sqrt_f32 v24, v24
    s_nop 0
    v_cvt_pk_bf16_f32 v24, v24, v24
    v_and_b32 v24, 0xffff0000, v24
    v_rcp_f32 v41, v24
    v_cndmask_b32 v28, v28, v29, s[24:25]
    v_cndmask_b32 v28, v28, v30, s[26:27]
    v_cndmask_b32 v28, v28, v31, s[28:29]
    v_mul_f32 v44, 0x3b000000, v44
    v_mul_f32 v28, 0x3b000000, v28
    v_fma_f32 v28, -v44, v44, v28
    v_max_f32 v28, 0, v28
    v_cvt_pk_bf16_f32 v28, v28, v28
    v_and_b32 v28, 0xffff0000, v28
    v_cvt_pk_bf16_f32 v44, v44, v44
    v_and_b32 v44, 0xffff0000, v44
    v_add_f32 v28, 0x3727c5ac, v28
    v_cvt_pk_bf16_f32 v28, v28, v28
    v_and_b32 v28, 0xffff0000, v28
    v_sqrt_f32 v28, v28
    s_nop 0
    v_cvt_pk_bf16_f32 v28, v28, v28
    v_and_b32 v28, 0xffff0000, v28
    v_rcp_f32 v45, v28
    s_and_saveexec_b64 s[30:31], vcc
    ds_write_b64 v5, v[32:33] offset:0
    ds_write_b64 v5, v[36:37] offset:128
    ds_write_b64 v5, v[40:41] offset:256
    ds_write_b64 v5, v[44:45] offset:384
    s_mov_b64 exec, s[30:31]
    s_waitcnt lgkmcnt(0)
    s_barrier
    v_and_b32 v9, 7, v2
    v_lshlrev_b32 v9, 7, v9
    v_mov_b32 v10, 1
    v_mov_b32 v12, 0
    s_lshl_b32 s21, s16, 10
    s_add_u32 s21, s21, 0x8000
    s_lshl_b32 s22, s17, 7
    s_add_u32 s22, s22, s21
    s_mov_b32 s38, 0x40000
    s_barrier
    s_mov_b64 exec, 1
    buffer_store_dword v10, v12, s[4:7], s22 offen sc1
    s_mov_b64 exec, -1
F_POLL:
    buffer_load_dword v11, v9, s[4:7], s21 offen sc1
    s_waitcnt vmcnt(0)
    v_cmp_ne_u32 vcc, 1, v11
    s_cbranch_vccz F_PD
    s_sleep 1
    s_sub_u32 s38, s38, 1
    s_cmp_lg_u32 s38, 0
    s_cbranch_scc1 F_POLL
F_PD:
    s_setprio 0
    s_branch F_P2
.section .rodata,"a"
.p2align 6
.amdhsa_kernel pc_kernel
  .amdhsa_next_free_vgpr 140
  .amdhsa_next_free_sgpr 64
  .amdhsa_accum_offset 140
  .amdhsa_group_segment_fixed_size 0
  .amdhsa_kernarg_size 152
  .amdhsa_user_sgpr_count 2
  .amdhsa_user_sgpr_kernarg_segment_ptr 1
  .amdhsa_system_sgpr_workgroup_id_x 1
.end_amdhsa_kernel
.p2align 6
.amdhsa_kernel ffn_kernel
  .amdhsa_next_free_vgpr 256
  .amdhsa_next_free_sgpr 64
  .amdhsa_accum_offset 256
  .amdhsa_group_segment_fixed_size 0
  .amdhsa_kernarg_size 152
  .amdhsa_user_sgpr_count 2
  .amdhsa_user_sgpr_kernarg_segment_ptr 1
  .amdhsa_system_sgpr_workgroup_id_x 1
.end_amdhsa_kernel
```
